```python
import torch

def _softmax(x, axis=-1):
    return torch.softmax(x, dim=axis)
def _gelu(x):
    return torch.nn.functional.gelu(x, approximate="tanh")
def _silu(x):
    return torch.nn.functional.silu(x)
def _sigmoid(x):
    return torch.sigmoid(x)
def _layernorm(x, axis=-1, eps=1e-5):
    m = x.mean(dim=axis, keepdim=True)
    v = x.var(dim=axis, keepdim=True, unbiased=False)
    return (x - m) / torch.sqrt(v + eps)
def _scatter_add(tgt, idx, src, axis=0):
    return tgt.clone().index_add_(axis, idx, src)
def _segment_sum(src, seg, n):
    out = torch.zeros((n,) + src.shape[1:], dtype=src.dtype)
    return out.index_add_(0, seg, src)
def _pad(x, pw):
    flat = tuple(v for pair in reversed(pw) for v in pair)
    return torch.nn.functional.pad(x, flat)

kernel_name = 'concat_heads__compressed_kv_cla__sliding_block_cached__decode'

def setup_inputs():

    _w = (lambda a: (lambda t: t.to(torch.bfloat16) if t.is_floating_point() else t)(torch.as_tensor(a)))
    def _A_setup():
        B, H, Sq, Sk, D, M = 1, 32, 1, 8192, 128, 576
        Dc = 4 * D
        return {
            "x": _w((lambda *s: torch.randn(*s, dtype=torch.bfloat16) * 3.2)(B, Sq, M)),
            "c_kv": _w((lambda *s: torch.randn(*s, dtype=torch.bfloat16) * 0.1)(B, Sk, Dc)),
            "w_q": _w((lambda *s: torch.randn(*s, dtype=torch.bfloat16) * 6.4)(M, H, D) * (M ** -0.5)),
            "w_uk": _w((lambda *s: torch.randn(*s, dtype=torch.bfloat16) * 6.4)(Dc, H, D) * (Dc ** -0.5)),
            "w_uv": _w((lambda *s: torch.randn(*s, dtype=torch.bfloat16) * 0.1)(Dc, H, D) * (Dc ** -0.5)),
            "w_o": _w((lambda *s: torch.randn(*s, dtype=torch.bfloat16) * 0.1)(H, D, M) * ((H * D) ** -0.5)),
        }
    _A_in = _A_setup()

    def _B_setup():
        B, Sq, D = 1, 1, 576
        Hq, Hkv, Sk, Dh = 32, 16, 8192, 128
        assert Hq % Hkv == 0, (Hq, Hkv)
        return {
            "x": _w((lambda *s: torch.randn(*s, dtype=torch.bfloat16) * 1.6)(B, Sq, D)),
            "k_cache": _w((lambda *s: torch.randn(*s, dtype=torch.bfloat16) * 1.6)(B, Hkv, Sk, Dh)),
            "v_cache": _w((lambda *s: torch.randn(*s, dtype=torch.bfloat16) * 0.05)(B, Hkv, Sk, Dh)),
            "wq": _w((lambda *s: torch.randn(*s, dtype=torch.bfloat16) * 1.6)(D, Hq * Dh) * (D ** -0.5)),
            "wo": _w((lambda *s: torch.randn(*s, dtype=torch.bfloat16) * 0.05)(Hq * Dh, D) * ((Hq * Dh) ** -0.5)),
        }
    _B_in = _B_setup()

    return {
        "A_x": _A_in["x"],
        "A_c_kv": _A_in["c_kv"],
        "A_w_q": _A_in["w_q"],
        "A_w_uk": _A_in["w_uk"],
        "A_w_uv": _A_in["w_uv"],
        "A_w_o": _A_in["w_o"],
        "B_x": _B_in["x"],
        "B_k_cache": _B_in["k_cache"],
        "B_v_cache": _B_in["v_cache"],
        "B_wq": _B_in["wq"],
        "B_wo": _B_in["wo"],
    }

def reference(A_x, A_c_kv, A_w_q, A_w_uk, A_w_uv, A_w_o, B_x, B_k_cache, B_v_cache, B_wq, B_wo):
    def _A_ref(x, c_kv, w_q, w_uk, w_uv, w_o):
        B, Sq, M = x.shape[0], x.shape[1], x.shape[2]
        Sk = c_kv.shape[1]
        H, D = w_q.shape[1], w_q.shape[2]
        q = torch.einsum("bqm,mhd->bhqd", x, w_q)
        k = torch.einsum("bkc,chd->bhkd", c_kv, w_uk)
        v = torch.einsum("bkc,chd->bhkd", c_kv, w_uv)
        scores = torch.einsum("bhqd,bhkd->bhqk", q, k) * (D ** -0.5)
        off = Sk - Sq
        qi = torch.arange(Sq)[:, None]
        kj = torch.arange(Sk)[None, :]
        cmask = kj <= (qi + off)
        scores = torch.where(cmask[None, None], scores, -1e9)
        p = _softmax(scores, axis=-1)
        ctx = torch.einsum("bhqk,bhkd->bhqd", p, v)
        return torch.einsum("bhqd,hdm->bqm", ctx, w_o)

    def _B_ref(x, k_cache, v_cache, wq, wo):
        B, Sq, D = x.shape
        Hq, Dh = 32, 128
        Hkv, Sk = k_cache.shape[1], k_cache.shape[2]
        W = min(4096, max(256, Sk // 4))
        rep = Hq // Hkv
        q = (lambda x, *d: x.permute(*d))((x @ wq).reshape(B, Sq, Hq, Dh), 0, 2, 1, 3)
        k = (lambda x, n, axis: torch.repeat_interleave(x, n, dim=axis))(k_cache[:, :, Sk - W:, :], rep, axis=1)
        v = (lambda x, n, axis: torch.repeat_interleave(x, n, dim=axis))(v_cache[:, :, Sk - W:, :], rep, axis=1)
        scores = torch.einsum("bhqd,bhkd->bhqk", q, k) * (Dh ** -0.5)
        p = _softmax(scores, axis=-1)
        o = torch.einsum("bhqk,bhkd->bhqd", p, v)
        return (lambda x, *d: x.permute(*d))(o, 0, 2, 1, 3).reshape(B, Sq, Hq * Dh) @ wo

    a = _A_ref(A_x, A_c_kv, A_w_q, A_w_uk, A_w_uv, A_w_o)
    b = _B_ref(B_x, B_k_cache, B_v_cache, B_wq, B_wo)
    return torch.concatenate([a, b], axis=-1)
```

```asm
; @launch grid=(256,1,1) block=(512,1,1) lds=154880
.amdgcn_target "amdgcn-amd-amdhsa--gfx950"
.text
.globl concat_heads__compressed_kv_cla__sliding_block_cached__decode_kernel
.p2align 8
.type concat_heads__compressed_kv_cla__sliding_block_cached__decode_kernel,@function
concat_heads__compressed_kv_cla__sliding_block_cached__decode_kernel:
    s_cmp_ge_u32 s2, 256
    s_cbranch_scc1 L_exit
    s_load_dwordx16 s[36:51], s[0:1], 0
    s_load_dwordx8 s[52:59], s[0:1], 64
    s_load_dwordx2 s[60:61], s[0:1], 104
    s_getpc_b64 s[30:31]
L_pc:
    v_lshrrev_b32 v1, 6, v0
    v_and_b32 v0, 63, v0
    s_bfe_u32 s6, s2, 0x20003
    s_lshl_b32 s6, s6, 12
    v_lshlrev_b32 v2, 9, v1
    v_lshl_add_u32 v2, v0, 7, v2
    v_add_u32 v2, s6, v2
    v_min_u32 v2, L_codeend-L_pc-4, v2
    s_mov_b64 exec, 15
    global_load_dword v251, v2, s[30:31]
    s_mov_b64 exec, -1
    v_readfirstlane_b32 s3, v1
    s_and_b32 s4, s2, 7
    s_lshl_b32 s4, s4, 4
    s_bfe_u32 s6, s2, 0x40003
    s_or_b32 s4, s4, s6
    v_and_b32 v1, 15, v0
    v_lshrrev_b32 v2, 4, v0
    v_and_b32 v3, 7, v0
    v_lshrrev_b32 v4, 3, v0
    v_lshlrev_b32 v20, 4, v0
    s_bitcmp1_b32 s2, 7
    s_cbranch_scc1 L_X0
    s_lshr_b32 s12, s4, 2
    s_and_b32 s13, s4, 3
    s_mul_i32 s8, s13, 144
    s_mul_i32 s9, s3, 18
    s_add_u32 s17, s8, s9
    v_add_u32 v10, s17, v2
    s_lshl_b32 s9, s12, 8
    v_lshlrev_b32 v10, 13, v10
    v_lshl_add_u32 v10, v1, 4, v10
    v_add_u32 v10, s9, v10
    v_xor_b32 v23, 256, v10
    s_xor_b32 s34, s4, 12
    s_lshl_b32 s17, s17, 1
    v_mov_b32 v40, 0
    v_mov_b32 v41, 0
    v_mov_b32 v42, 0
    v_mov_b32 v43, 0
    s_waitcnt lgkmcnt(0)
    global_load_dwordx4 v[24:27], v10, s[40:41] nt
    v_add_u32 v10, 0x8000, v10
    global_load_dwordx4 v[28:31], v10, s[40:41] nt
    v_add_u32 v10, 0x8000, v10
    global_load_dwordx4 v[32:35], v10, s[40:41] nt
    v_add_u32 v10, 0x8000, v10
    global_load_dwordx4 v[36:39], v10, s[40:41] nt
    v_add_u32 v10, 0x8000, v10
    s_mov_b32 exec_hi, 0
    global_load_dwordx4 v[40:43], v10, s[40:41] nt
    s_mov_b32 exec_hi, -1
    s_add_u32 s6, s36, s17
    s_addc_u32 s7, s37, 0
    s_load_dwordx8 s[64:71], s[6:7], 0
    s_load_dword s28, s[6:7], 32
    s_load_dword s62, s[60:61], 0
    s_add_u32 s6, s48, s17
    s_addc_u32 s7, s49, 0
    s_load_dwordx8 s[20:27], s[6:7], 0
    s_load_dword s29, s[6:7], 32
    s_lshl_b32 s8, s13, 7
    s_lshl_b32 s10, s3, 4
    s_add_u32 s8, s8, s10
    v_add_u32 v22, s8, v2
    v_lshlrev_b32 v22, 13, v22
    v_xor_b32 v220, v1, v2
    v_lshlrev_b32 v220, 4, v220
    s_xor_b32 s9, s9, 768
    v_add3_u32 v22, s9, v22, v220
    s_lshl_b32 s11, s3, 12
    v_and_b32 v17, 1, v2
    v_mul_u32_u24 v17, 0x0202, v17
    v_mul_u32_u24 v17, 0x010001, v17
    v_add_u32 v17, 0x01000100, v17
    v_and_b32 v200, 1, v0
    v_lshlrev_b32 v200, 4, v200
    v_mov_b32 v202, 0xffff
    v_lshlrev_b32 v200, v200, v202
    s_mov_b32 s6, 0x3030303
    s_mov_b32 s7, 0x3030303
    v_cndmask_b32 v5, 0, v200, s[6:7]
    s_mov_b32 s6, 0xc0c0c0c
    s_mov_b32 s7, 0xc0c0c0c
    v_cndmask_b32 v6, 0, v200, s[6:7]
    s_mov_b32 s6, 0x30303030
    s_mov_b32 s7, 0x30303030
    v_cndmask_b32 v7, 0, v200, s[6:7]
    s_mov_b32 s6, 0xc0c0c0c0
    s_mov_b32 s7, 0xc0c0c0c0
    v_cndmask_b32 v8, 0, v200, s[6:7]
    s_waitcnt lgkmcnt(0)
    s_add_u32 s62, s62, 1
    s_mul_i32 s63, s62, 0x9E3779B1
    s_and_b32 s63, s63, 0xBFFFBFFF
    v_mov_b32 v9, s63
    s_mov_b32 s18, s63
    s_mov_b32 s19, s63
    s_mov_b32 exec_hi, 0
    v_mov_b32 v12, s64
    v_mov_b32 v13, s66
    v_mov_b32 v14, s68
    v_mov_b32 v15, s70
    v_mov_b32 v16, s28
    s_mov_b32 exec_lo, 0x0
    s_mov_b32 exec_hi, 0xffffffff
    v_mov_b32 v12, s65
    v_mov_b32 v13, s67
    v_mov_b32 v14, s69
    v_mov_b32 v15, s71
    v_mov_b32 v16, 0
    s_mov_b64 exec, -1
    v_perm_b32 v12, v12, v12, v17
    v_perm_b32 v13, v13, v13, v17
    v_perm_b32 v14, v14, v14, v17
    v_perm_b32 v15, v15, v15, v17
    v_perm_b32 v16, v16, v16, v17
    v_and_b32 v176, v12, v5
    v_and_b32 v177, v12, v6
    v_and_b32 v178, v12, v7
    v_and_b32 v179, v12, v8
    v_and_b32 v180, v13, v5
    v_and_b32 v181, v13, v6
    v_and_b32 v182, v13, v7
    v_and_b32 v183, v13, v8
    v_and_b32 v184, v14, v5
    v_and_b32 v185, v14, v6
    v_and_b32 v186, v14, v7
    v_and_b32 v187, v14, v8
    v_and_b32 v188, v15, v5
    v_and_b32 v189, v15, v6
    v_and_b32 v190, v15, v7
    v_and_b32 v191, v15, v8
    v_and_b32 v192, v16, v5
    v_and_b32 v193, v16, v6
    v_and_b32 v194, v16, v7
    v_and_b32 v195, v16, v8
    s_add_u32 m0, s11, 16384
    v_xor_b32 v10, 0x0, v22
    global_load_lds_dwordx4 v10, s[42:43] nt
    s_add_u32 m0, s11, 17408
    v_xor_b32 v10, 0x8040, v22
    global_load_lds_dwordx4 v10, s[42:43] nt
    s_add_u32 m0, s11, 18432
    v_xor_b32 v10, 0x10080, v22
    global_load_lds_dwordx4 v10, s[42:43] nt
    s_add_u32 m0, s11, 19456
    v_xor_b32 v10, 0x180c0, v22
    global_load_lds_dwordx4 v10, s[42:43] nt
    v_lshl_add_u32 v224, v1, 8, v220
    v_add_u32 v224, s11, v224
    v_xor_b32 v225, 0x40, v224
    v_xor_b32 v226, 0x80, v224
    v_xor_b32 v227, 0xc0, v224
    s_lshl_b32 s6, s3, 9
    v_lshlrev_b32 v21, 5, v1
    v_lshl_add_u32 v21, v2, 4, v21
    v_add_u32 v21, s6, v21
    v_lshlrev_b32 v228, 3, v0
    v_lshlrev_b32 v229, 2, v0
    s_lshl_b32 s6, s4, 10
    s_add_u32 s6, s6, 65536
    v_add_u32 v230, s6, v20
    v_xor_b32 v231, 4096, v230
    v_add_u32 v231, 131072, v231
    s_lshr_b32 s6, s34, 2
    s_lshl_b32 s6, s6, 12
    s_add_u32 s6, s6, 65536
    v_add_u32 v232, s6, v20
    s_lshl_b32 s6, s34, 9
    s_add_u32 s6, s6, 327680
    v_add_u32 v233, s6, v20
    s_lshl_b32 s6, s3, 5
    v_lshl_add_u32 v234, v2, 3, s6
    v_lshlrev_b32 v235, 4, v2
    s_lshr_b32 s6, s4, 6
    v_lshl_add_u32 v236, v0, 1, s6
    s_bfe_u32 s6, s34, 0x30003
    s_lshl_b32 s6, s6, 7
    s_and_b32 s7, s34, 7
    s_lshl_b32 s7, s7, 2
    s_add_u32 s6, s6, s7
    s_add_u32 s6, s6, 393216
    v_lshl_add_u32 v236, v236, 10, s6
    s_mov_b32 s14, 0x3e0293ee
    s_lshr_b32 s15, s4, 3
    s_and_b32 s16, s4, 7
    s_lshl_b32 s6, s15, 21
    s_lshl_b32 s7, s16, 16
    s_add_u32 s6, s6, s7
    s_lshl_b32 s10, s3, 13
    s_add_u32 s6, s6, s10
    s_add_u32 s6, s6, 1574912
    v_lshl_add_u32 v18, v2, 8, v220
    s_sub_u32 s7, s6, 2048
    v_add_u32 v18, s7, v18
    v_lshlrev_b32 v11, 10, v2
    v_lshl_add_u32 v11, v1, 4, v11
    v_add_u32 v11, s6, v11
    s_lshl_b32 s6, s15, 1
    s_and_b32 s7, s3, 1
    s_add_u32 s6, s6, s7
    s_lshl_b32 s6, s6, 12
    s_add_u32 s6, s6, 196608
    v_add_u32 v237, s6, v20
    s_lshl_b32 s7, s7, 8
    v_add_u32 v238, s7, v229
    v_mov_b32 v76, 0
    v_mov_b32 v77, 0
    v_mov_b32 v78, 0
    v_mov_b32 v79, 0
    s_getreg_b32 s31, hwreg(HW_REG_XCC_ID, 0, 4)
    s_lshl_b32 s31, s31, 4
    s_xor_b32 s31, s31, s63
    s_lshr_b32 s30, s4, 4
    s_lshl_b32 s30, s30, 7
    s_add_u32 s30, s30, 4096
    s_mov_b32 exec_hi, 0
    v_mov_b32 v12, s20
    v_mov_b32 v13, s22
    v_mov_b32 v14, s24
    v_mov_b32 v15, s26
    v_mov_b32 v16, s29
    s_mov_b32 exec_lo, 0x0
    s_mov_b32 exec_hi, 0xffffffff
    v_mov_b32 v12, s21
    v_mov_b32 v13, s23
    v_mov_b32 v14, s25
    v_mov_b32 v15, s27
    v_mov_b32 v16, 0
    s_mov_b64 exec, -1
    v_perm_b32 v12, v12, v12, v17
    v_perm_b32 v13, v13, v13, v17
    v_perm_b32 v14, v14, v14, v17
    v_perm_b32 v15, v15, v15, v17
    v_perm_b32 v16, v16, v16, v17
    v_and_b32 v80, v12, v5
    v_and_b32 v81, v12, v6
    v_and_b32 v82, v12, v7
    v_and_b32 v83, v12, v8
    v_and_b32 v84, v13, v5
    v_and_b32 v85, v13, v6
    v_and_b32 v86, v13, v7
    v_and_b32 v87, v13, v8
    v_and_b32 v88, v14, v5
    v_and_b32 v89, v14, v6
    v_and_b32 v90, v14, v7
    v_and_b32 v91, v14, v8
    v_and_b32 v92, v15, v5
    v_and_b32 v93, v15, v6
    v_and_b32 v94, v15, v7
    v_and_b32 v95, v15, v8
    v_and_b32 v96, v16, v5
    v_and_b32 v97, v16, v6
    v_and_b32 v98, v16, v7
    v_and_b32 v99, v16, v8
    s_waitcnt vmcnt(8)
    v_mfma_f32_16x16x32_bf16 v[196:199], v[176:179], v[24:27], 0
    s_waitcnt vmcnt(7)
    v_mfma_f32_16x16x32_bf16 v[196:199], v[180:183], v[28:31], v[196:199]
    s_waitcnt vmcnt(6)
    v_mfma_f32_16x16x32_bf16 v[196:199], v[184:187], v[32:35], v[196:199]
    s_waitcnt vmcnt(5)
    global_load_dwordx4 v[60:63], v23, s[54:55] nt
    s_mov_b32 exec_hi, -1
    s_nop 0
    v_mfma_f32_16x16x32_bf16 v[196:199], v[188:191], v[36:39], v[196:199]
    s_waitcnt vmcnt(5)
    v_add_u32 v23, 0x8000, v23
    global_load_dwordx4 v[64:67], v23, s[54:55] nt
    s_mov_b32 exec_hi, -1
    s_nop 0
    v_mfma_f32_16x16x32_bf16 v[196:199], v[192:195], v[40:43], v[196:199]
    s_mov_b32 exec_hi, 0
    s_nop 6
    ds_write_b128 v21, v[196:199]
    s_mov_b32 exec_hi, -1
    s_waitcnt lgkmcnt(0)
    s_barrier
    s_cmp_lg_u32 s3, 0
    s_cbranch_scc1 L_y1_1
    ds_read2st64_b64 v[204:207], v228 offset0:0 offset1:1
    ds_read2st64_b64 v[208:211], v228 offset0:2 offset1:3
    ds_read2st64_b64 v[212:215], v228 offset0:4 offset1:5
    ds_read2st64_b64 v[216:219], v228 offset0:6 offset1:7
    s_waitcnt lgkmcnt(2)
    v_add_f32 v204, v204, v206
    v_add_f32 v205, v205, v207
    v_add_f32 v208, v208, v210
    v_add_f32 v209, v209, v211
    v_add_f32 v204, v204, v208
    v_add_f32 v206, v205, v209
    v_mov_b32 v205, v9
    v_mov_b32 v207, v9
    s_waitcnt lgkmcnt(0)
    v_add_f32 v212, v212, v214
    v_add_f32 v213, v213, v215
    v_add_f32 v216, v216, v218
    v_add_f32 v217, v217, v219
    v_add_f32 v212, v212, v216
    v_add_f32 v213, v213, v217
    v_add_f32 v204, v204, v212
    v_add_f32 v206, v206, v213
    global_store_dwordx4 v230, v[204:207], s[60:61] sc1
    s_waitcnt vmcnt(0)
    s_nop 0
    global_load_dwordx4 v[204:207], v232, s[60:61] offset:0 sc1
    global_load_dwordx4 v[208:211], v232, s[60:61] offset:1024 sc1
    global_load_dwordx4 v[212:215], v232, s[60:61] offset:2048 sc1
    global_load_dwordx4 v[216:219], v232, s[60:61] offset:3072 sc1
    s_branch L_y1b_2
L_y1_1:
    s_waitcnt vmcnt(2)
L_y1b_2:
    s_barrier
    v_add_u32 v23, 0x8000, v23
    global_load_dwordx4 v[68:71], v23, s[54:55] nt
    v_add_u32 v23, 0x8000, v23
    global_load_dwordx4 v[72:75], v23, s[54:55] nt
    v_add_u32 v23, 0x8000, v23
    s_mov_b32 exec_hi, 0
    global_load_dwordx4 v[76:79], v23, s[54:55] nt
    s_mov_b32 exec_hi, -1
    s_cmp_lg_u32 s3, 0
    s_cbranch_scc1 L_y1c_3
    s_mov_b32 s5, 0
    s_waitcnt vmcnt(3)
    v_xor_b32 v202, v9, v205
    v_xor_b32 v203, v9, v207
    v_bitop3_b32 v202, v209, v9, v202 bitop3:0xbe
    v_bitop3_b32 v203, v211, v9, v203 bitop3:0xbe
    v_bitop3_b32 v202, v213, v9, v202 bitop3:0xbe
    v_bitop3_b32 v203, v215, v9, v203 bitop3:0xbe
    v_bitop3_b32 v202, v217, v9, v202 bitop3:0xbe
    v_bitop3_b32 v203, v219, v9, v203 bitop3:0xbe
    v_or_b32 v202, v202, v203
    v_cmp_ne_u32 vcc, 0, v202
    s_nop 1
    s_and_b64 exec, vcc, vcc
    s_cbranch_scc0 L_h1ok_5
L_h1_4:
    global_load_dwordx4 v[204:207], v232, s[60:61] offset:0 sc1
    global_load_dwordx4 v[208:211], v232, s[60:61] offset:1024 sc1
    global_load_dwordx4 v[212:215], v232, s[60:61] offset:2048 sc1
    global_load_dwordx4 v[216:219], v232, s[60:61] offset:3072 sc1
    s_add_u32 s5, s5, 1
    s_cmp_ge_u32 s5, 1000000
    s_cbranch_scc1 L_bail
    s_waitcnt vmcnt(0)
    v_xor_b32 v202, v9, v205
    v_xor_b32 v203, v9, v207
    v_bitop3_b32 v202, v209, v9, v202 bitop3:0xbe
    v_bitop3_b32 v203, v211, v9, v203 bitop3:0xbe
    v_bitop3_b32 v202, v213, v9, v202 bitop3:0xbe
    v_bitop3_b32 v203, v215, v9, v203 bitop3:0xbe
    v_bitop3_b32 v202, v217, v9, v202 bitop3:0xbe
    v_bitop3_b32 v203, v219, v9, v203 bitop3:0xbe
    v_or_b32 v202, v202, v203
    v_cmp_ne_u32 vcc, 0, v202
    s_nop 1
    s_and_b64 exec, vcc, vcc
    s_cbranch_scc1 L_h1_4
L_h1ok_5:
    s_mov_b64 exec, -1
    v_add_f32 v204, v204, v208
    v_add_f32 v206, v206, v210
    v_add_f32 v212, v212, v216
    v_add_f32 v214, v214, v218
    v_add_f32 v204, v204, v212
    v_add_f32 v206, v206, v214
    v_cvt_pk_bf16_f32 v204, v204, v206
    ds_write_b32 v229, v204 offset:4096
    s_waitcnt lgkmcnt(0)
L_y1c_3:
    ds_read_b128 v[44:47], v224 offset:16384
    ds_read_b128 v[48:51], v225 offset:16384
    ds_read_b128 v[52:55], v226 offset:16384
    ds_read_b128 v[56:59], v227 offset:16384
    v_add_u32 v224, s11, v224
    v_add_u32 v225, s11, v225
    v_add_u32 v226, s11, v226
    v_add_u32 v227, s11, v227
    v_mov_b32 v205, v9
    v_mov_b32 v207, v9
    s_barrier
    ds_read_b128 v[176:179], v235 offset:4096
    ds_read_b128 v[180:183], v235 offset:4160
    ds_read_b128 v[184:187], v235 offset:4224
    ds_read_b128 v[188:191], v235 offset:4288
    s_waitcnt lgkmcnt(3)
    v_mfma_f32_16x16x32_bf16 v[196:199], v[44:47], v[176:179], 0
    s_waitcnt lgkmcnt(2)
    v_mfma_f32_16x16x32_bf16 v[196:199], v[48:51], v[180:183], v[196:199]
    s_waitcnt lgkmcnt(1)
    v_mfma_f32_16x16x32_bf16 v[196:199], v[52:55], v[184:187], v[196:199]
    s_waitcnt lgkmcnt(0)
    v_mfma_f32_16x16x32_bf16 v[196:199], v[56:59], v[188:191], v[196:199]
    s_nop 7
    v_mul_f32 v196, s14, v196
    v_mul_f32 v197, s14, v197
    v_mul_f32 v198, s14, v198
    v_mul_f32 v199, s14, v199
    v_cvt_pk_bf16_f32 v196, v196, v197
    v_cvt_pk_bf16_f32 v197, v198, v199
    s_mov_b32 exec_lo, 0x10001
    s_mov_b32 exec_hi, 0x10001
    ds_write_b64 v234, v[196:197] offset:6400
    s_mov_b64 exec, -1
    s_waitcnt lgkmcnt(0)
    s_barrier
    s_cmp_lg_u32 s3, 0
    s_cbranch_scc1 L_y2_6
    ds_read_b64 v[208:209], v228 offset:6400
    s_mov_b32 exec_hi, 0
    s_waitcnt lgkmcnt(0)
    v_mov_b32 v204, v208
    v_mov_b32 v206, v209
    global_store_dwordx4 v233, v[204:207], s[60:61] sc1
    s_mov_b32 exec_hi, -1
L_y2_6:
    s_barrier
    s_cmp_lg_u32 s3, 7
    s_cbranch_scc1 L_dp_7
    s_and_b32 s6, s4, 15
    s_lshl_b32 s6, s6, 2
    s_add_u32 s6, s6, s30
    v_mov_b32 v200, s6
    v_mov_b32 v202, s31
    s_mov_b64 exec, 1
    global_store_dword v200, v202, s[60:61] sc1
    s_mov_b64 exec, -1
L_dp_7:
    s_mov_b32 exec_hi, -1
    s_lshl_b32 s6, s3, 15
    s_lshl_b32 s7, s4, 7
    s_add_u32 s6, s6, s7
    s_add_u32 s6, s6, 1343488
    v_and_b32 v240, 1, v2
    v_lshlrev_b32 v240, 14, v240
    v_lshrrev_b32 v241, 1, v2
    v_lshl_add_u32 v240, v241, 6, v240
    v_lshl_add_u32 v240, v1, 3, v240
    v_add_u32 v240, s6, v240
    v_add_u32 v241, 0x8000, v240
    s_lshl_b32 s6, s15, 13
    s_lshl_b32 s7, s16, 7
    s_add_u32 s6, s6, s7
    s_add_u32 s6, s6, 786432
    v_lshlrev_b32 v19, 10, v4
    v_lshl_add_u32 v19, v3, 4, v19
    v_add_u32 v19, s6, v19
    s_lshl_b32 s6, s4, 10
    s_add_u32 s6, s6, 786432
    v_lshlrev_b32 v242, 7, v3
    v_lshl_add_u32 v242, v4, 4, v242
    v_add_u32 v242, s6, v242
    s_lshl_b32 s6, s4, 5
    v_lshl_add_u32 v15, v4, 2, s6
    v_mul_u32_u24 v15, 1152, v15
    v_lshl_add_u32 v15, v3, 4, v15
    s_lshl_b32 s6, s3, 7
    v_add_u32 v16, s6, v15
    v_add_u32 v15, 0x400, v15
    v_lshrrev_b32 v12, 3, v1
    v_lshlrev_b32 v13, 5, v12
    s_lshl_b32 s6, s3, 2
    v_add_u32 v14, s6, v13
    v_lshl_add_u32 v22, v12, 8, v235
    s_lshl_b32 s6, s3, 10
    s_add_u32 s6, s6, 8192
    v_lshrrev_b32 v243, 1, v2
    v_lshlrev_b32 v243, 9, v243
    v_lshl_add_u32 v243, v1, 5, v243
    v_and_b32 v244, 1, v2
    v_lshl_add_u32 v243, v244, 4, v243
    v_add_u32 v243, s6, v243
    v_lshrrev_b32 v244, 5, v0
    v_lshlrev_b32 v244, 5, v244
    s_add_u32 m0, s10, 49152
    v_xor_b32 v10, 0x0, v18
    global_load_lds_dwordx4 v10, s[50:51] offset:0 nt
    s_waitcnt vmcnt(5)
    v_mfma_f32_16x16x32_bf16 v[196:199], v[80:83], v[60:63], 0
    s_waitcnt vmcnt(4)
    v_mfma_f32_16x16x32_bf16 v[196:199], v[84:87], v[64:67], v[196:199]
    s_waitcnt vmcnt(3)
    v_mfma_f32_16x16x32_bf16 v[196:199], v[88:91], v[68:71], v[196:199]
    s_waitcnt vmcnt(2)
    v_mfma_f32_16x16x32_bf16 v[196:199], v[92:95], v[72:75], v[196:199]
    s_waitcnt vmcnt(1)
    v_mfma_f32_16x16x32_bf16 v[196:199], v[96:99], v[76:79], v[196:199]
    s_mov_b32 exec_hi, 0
    s_nop 6
    ds_write_b128 v21, v[196:199]
    s_mov_b32 exec_hi, -1
    s_waitcnt lgkmcnt(0)
    s_barrier
    s_cmp_lg_u32 s3, 0
    s_cbranch_scc1 L_y3_8
    ds_read2st64_b64 v[204:207], v228 offset0:0 offset1:1
    ds_read2st64_b64 v[208:211], v228 offset0:2 offset1:3
    ds_read2st64_b64 v[212:215], v228 offset0:4 offset1:5
    ds_read2st64_b64 v[216:219], v228 offset0:6 offset1:7
    s_waitcnt lgkmcnt(2)
    v_add_f32 v204, v204, v206
    v_add_f32 v205, v205, v207
    v_add_f32 v208, v208, v210
    v_add_f32 v209, v209, v211
    v_add_f32 v204, v204, v208
    v_add_f32 v206, v205, v209
    v_mov_b32 v205, v9
    v_mov_b32 v207, v9
    s_waitcnt lgkmcnt(0)
    v_add_f32 v212, v212, v214
    v_add_f32 v213, v213, v215
    v_add_f32 v216, v216, v218
    v_add_f32 v217, v217, v219
    v_add_f32 v212, v212, v216
    v_add_f32 v213, v213, v217
    v_add_f32 v204, v204, v212
    v_add_f32 v206, v206, v213
    global_store_dwordx4 v231, v[204:207], s[60:61] sc1
L_y3_8:
    s_barrier
    s_lshl_b32 s6, s3, 15
    s_lshl_b32 s7, s4, 7
    s_add_u32 s6, s6, s7
    s_add_u32 s6, s6, 1343488
    s_add_u32 s6, s60, s6
    s_addc_u32 s7, s61, 0
    s_load_dword s100, s[6:7], 0
    s_load_dword s100, s[6:7], 64
    s_load_dword s100, s[6:7], 16384
    s_load_dword s100, s[6:7], 16448
    s_cmp_lg_u32 s3, 7
    s_cbranch_scc1 L_wl_9
    s_load_dword s100, s[6:7], 32768
    s_load_dword s100, s[6:7], 32832
    s_load_dword s100, s[6:7], 49152
    s_load_dword s100, s[6:7], 49216
L_wl_9:
    s_lshl_b32 s6, s15, 13
    s_lshl_b32 s7, s16, 7
    s_add_u32 s6, s6, s7
    s_lshl_b32 s7, s3, 10
    s_add_u32 s6, s6, s7
    s_add_u32 s6, s6, 786432
    s_add_u32 s6, s60, s6
    s_addc_u32 s7, s61, 0
    s_load_dword s100, s[6:7], 0
    s_load_dword s100, s[6:7], 64
    v_xor_b32 v10, 0x40, v18
    global_load_lds_dwordx4 v10, s[50:51] offset:1024 nt
    v_xor_b32 v10, 0x80, v18
    global_load_lds_dwordx4 v10, s[50:51] offset:2048 nt
    v_xor_b32 v10, 0xc0, v18
    global_load_lds_dwordx4 v10, s[50:51] offset:3072 nt
    s_add_u32 m0, s10, 53248
    v_xor_b32 v10, 0x1000, v18
    global_load_lds_dwordx4 v10, s[50:51] offset:0 nt
    v_xor_b32 v10, 0x1040, v18
    global_load_lds_dwordx4 v10, s[50:51] offset:1024 nt
    v_xor_b32 v10, 0x1080, v18
    global_load_lds_dwordx4 v10, s[50:51] offset:2048 nt
    v_xor_b32 v10, 0x10c0, v18
    global_load_lds_dwordx4 v10, s[50:51] offset:3072 nt
    s_barrier
    global_load_dwordx4 v[112:115], v11, s[52:53] offset:-2048 nt
    s_cmp_gt_u32 s3, 1
    s_cbranch_scc1 L_y4_10
    global_load_dwordx4 v[204:207], v237, s[60:61] offset:0 sc1
    global_load_dwordx4 v[208:211], v237, s[60:61] offset:1024 sc1
    global_load_dwordx4 v[212:215], v237, s[60:61] offset:2048 sc1
    global_load_dwordx4 v[216:219], v237, s[60:61] offset:3072 sc1
L_y4_10:
    global_load_dwordx4 v[116:119], v11, s[52:53] offset:-1792 nt
    global_load_dwordx4 v[120:123], v11, s[52:53] offset:-1536 nt
    global_load_dwordx4 v[124:127], v11, s[52:53] offset:-1280 nt
    global_load_dwordx4 v[128:131], v11, s[52:53] offset:2048 nt
    global_load_dwordx4 v[132:135], v11, s[52:53] offset:2304 nt
    global_load_dwordx4 v[136:139], v11, s[52:53] offset:2560 nt
    global_load_dwordx4 v[140:143], v11, s[52:53] offset:2816 nt
    s_cmp_gt_u32 s3, 1
    s_cbranch_scc1 L_y5_11
    s_mov_b32 s5, 0
    s_waitcnt vmcnt(7)
    v_xor_b32 v202, v9, v205
    v_xor_b32 v203, v9, v207
    v_bitop3_b32 v202, v209, v9, v202 bitop3:0xbe
    v_bitop3_b32 v203, v211, v9, v203 bitop3:0xbe
    v_bitop3_b32 v202, v213, v9, v202 bitop3:0xbe
    v_bitop3_b32 v203, v215, v9, v203 bitop3:0xbe
    v_bitop3_b32 v202, v217, v9, v202 bitop3:0xbe
    v_bitop3_b32 v203, v219, v9, v203 bitop3:0xbe
    v_or_b32 v202, v202, v203
    v_cmp_ne_u32 vcc, 0, v202
    s_nop 1
    s_and_b64 exec, vcc, vcc
    s_cbranch_scc0 L_h1bok_13
L_h1b_12:
    global_load_dwordx4 v[204:207], v237, s[60:61] offset:0 sc1
    global_load_dwordx4 v[208:211], v237, s[60:61] offset:1024 sc1
    global_load_dwordx4 v[212:215], v237, s[60:61] offset:2048 sc1
    global_load_dwordx4 v[216:219], v237, s[60:61] offset:3072 sc1
    s_add_u32 s5, s5, 1
    s_cmp_ge_u32 s5, 1000000
    s_cbranch_scc1 L_bail
    s_waitcnt vmcnt(0)
    v_xor_b32 v202, v9, v205
    v_xor_b32 v203, v9, v207
    v_bitop3_b32 v202, v209, v9, v202 bitop3:0xbe
    v_bitop3_b32 v203, v211, v9, v203 bitop3:0xbe
    v_bitop3_b32 v202, v213, v9, v202 bitop3:0xbe
    v_bitop3_b32 v203, v215, v9, v203 bitop3:0xbe
    v_bitop3_b32 v202, v217, v9, v202 bitop3:0xbe
    v_bitop3_b32 v203, v219, v9, v203 bitop3:0xbe
    v_or_b32 v202, v202, v203
    v_cmp_ne_u32 vcc, 0, v202
    s_nop 1
    s_and_b64 exec, vcc, vcc
    s_cbranch_scc1 L_h1b_12
L_h1bok_13:
    s_mov_b64 exec, -1
    v_add_f32 v204, v204, v208
    v_add_f32 v206, v206, v210
    v_add_f32 v212, v212, v216
    v_add_f32 v214, v214, v218
    v_add_f32 v204, v204, v212
    v_add_f32 v206, v206, v214
    v_cvt_pk_bf16_f32 v204, v204, v206
    ds_write_b32 v238, v204 offset:4352
    s_waitcnt lgkmcnt(0)
L_y5_11:
    s_add_u32 s6, s60, s30
    s_addc_u32 s7, s61, 0
    s_load_dwordx8 s[64:71], s[6:7], 0
    s_load_dwordx8 s[20:27], s[6:7], 32
    s_waitcnt vmcnt(8)
    ds_read_b128 v[80:83], v224 offset:49152
    ds_read_b128 v[84:87], v225 offset:49152
    ds_read_b128 v[88:91], v226 offset:49152
    ds_read_b128 v[92:95], v227 offset:49152
    ds_read_b128 v[96:99], v224 offset:53248
    ds_read_b128 v[100:103], v225 offset:53248
    ds_read_b128 v[104:107], v226 offset:53248
    ds_read_b128 v[108:111], v227 offset:53248
    s_barrier
    ds_read_b128 v[176:179], v22 offset:4352
    ds_read_b128 v[180:183], v22 offset:4416
    ds_read_b128 v[184:187], v22 offset:4480
    ds_read_b128 v[188:191], v22 offset:4544
    s_waitcnt lgkmcnt(0)
    v_mfma_f32_16x16x32_bf16 v[192:195], v[80:83], v[176:179], 0
    v_mfma_f32_16x16x32_bf16 v[196:199], v[96:99], v[176:179], 0
    v_mfma_f32_16x16x32_bf16 v[192:195], v[84:87], v[180:183], v[192:195]
    v_mfma_f32_16x16x32_bf16 v[196:199], v[100:103], v[180:183], v[196:199]
    v_mfma_f32_16x16x32_bf16 v[192:195], v[88:91], v[184:187], v[192:195]
    v_mfma_f32_16x16x32_bf16 v[196:199], v[104:107], v[184:187], v[196:199]
    v_mfma_f32_16x16x32_bf16 v[192:195], v[92:95], v[188:191], v[192:195]
    v_mfma_f32_16x16x32_bf16 v[196:199], v[108:111], v[188:191], v[196:199]
    s_mov_b32 s6, s31
    s_mov_b32 s7, s31
    s_xor_b64 s[64:65], s[64:65], s[6:7]
    s_xor_b64 s[66:67], s[66:67], s[6:7]
    s_xor_b64 s[68:69], s[68:69], s[6:7]
    s_xor_b64 s[70:71], s[70:71], s[6:7]
    s_xor_b64 s[20:21], s[20:21], s[6:7]
    s_xor_b64 s[22:23], s[22:23], s[6:7]
    s_xor_b64 s[24:25], s[24:25], s[6:7]
    s_xor_b64 s[26:27], s[26:27], s[6:7]
    s_or_b64 s[64:65], s[64:65], s[66:67]
    s_or_b64 s[64:65], s[64:65], s[68:69]
    s_or_b64 s[64:65], s[64:65], s[70:71]
    s_or_b64 s[64:65], s[64:65], s[20:21]
    s_or_b64 s[64:65], s[64:65], s[22:23]
    s_or_b64 s[64:65], s[64:65], s[24:25]
    s_or_b64 s[64:65], s[64:65], s[26:27]
    s_cselect_b32 s101, 0, 1
    v_max3_f32 v200, v192, v193, v194
    v_max3_f32 v201, v196, v197, v198
    v_max3_f32 v200, v200, v195, v199
    v_max_f32 v200, v200, v201
    v_mov_b32 v202, v200
    s_nop 1
    v_permlane16_swap_b32 v200, v202
    v_max_f32 v200, v200, v202
    v_mov_b32 v202, v200
    s_nop 1
    v_permlane32_swap_b32 v200, v202
    v_max_f32 v200, v200, v202
    s_mov_b32 exec_lo, 0x101
    s_mov_b32 exec_hi, 0x0
    ds_write_b32 v14, v200 offset:5120
    s_mov_b64 exec, -1
    s_waitcnt lgkmcnt(0)
    s_barrier
    ds_read_b128 v[204:207], v13 offset:5120
    ds_read_b128 v[208:211], v13 offset:5136
    s_waitcnt lgkmcnt(0)
    v_max3_f32 v200, v204, v205, v206
    v_max3_f32 v201, v207, v208, v209
    v_max3_f32 v200, v200, v210, v211
    v_max_f32 v200, v200, v201
    v_mul_f32 v200, s14, v200
    v_fma_f32 v192, v192, s14, -v200
    v_fma_f32 v193, v193, s14, -v200
    v_fma_f32 v194, v194, s14, -v200
    v_fma_f32 v195, v195, s14, -v200
    v_fma_f32 v196, v196, s14, -v200
    v_fma_f32 v197, v197, s14, -v200
    v_fma_f32 v198, v198, s14, -v200
    v_fma_f32 v199, v199, s14, -v200
    v_exp_f32 v192, v192
    v_exp_f32 v193, v193
    v_exp_f32 v194, v194
    v_exp_f32 v195, v195
    v_exp_f32 v196, v196
    v_exp_f32 v197, v197
    v_exp_f32 v198, v198
    v_exp_f32 v199, v199
    v_cvt_pk_bf16_f32 v204, v192, v192
    v_cvt_pk_bf16_f32 v205, v193, v193
    v_cvt_pk_bf16_f32 v206, v194, v194
    v_cvt_pk_bf16_f32 v207, v195, v195
    v_cvt_pk_bf16_f32 v208, v196, v196
    v_cvt_pk_bf16_f32 v209, v197, v197
    v_cvt_pk_bf16_f32 v210, v198, v198
    v_cvt_pk_bf16_f32 v211, v199, v199
    v_and_b32 v80, v204, v5
    v_and_b32 v81, v204, v6
    v_and_b32 v82, v204, v7
    v_and_b32 v83, v204, v8
    v_and_b32 v84, v205, v5
    v_and_b32 v85, v205, v6
    v_and_b32 v86, v205, v7
    v_and_b32 v87, v205, v8
    v_and_b32 v88, v206, v5
    v_and_b32 v89, v206, v6
    v_and_b32 v90, v206, v7
    v_and_b32 v91, v206, v8
    v_and_b32 v92, v207, v5
    v_and_b32 v93, v207, v6
    v_and_b32 v94, v207, v7
    v_and_b32 v95, v207, v8
    v_and_b32 v96, v208, v5
    v_and_b32 v97, v208, v6
    v_and_b32 v98, v208, v7
    v_and_b32 v99, v208, v8
    v_and_b32 v100, v209, v5
    v_and_b32 v101, v209, v6
    v_and_b32 v102, v209, v7
    v_and_b32 v103, v209, v8
    v_and_b32 v104, v210, v5
    v_and_b32 v105, v210, v6
    v_and_b32 v106, v210, v7
    v_and_b32 v107, v210, v8
    v_and_b32 v108, v211, v5
    v_and_b32 v109, v211, v6
    v_and_b32 v110, v211, v7
    v_and_b32 v111, v211, v8
    v_add_f32 v192, v192, v193
    v_add_f32 v194, v194, v195
    v_add_f32 v196, v196, v197
    v_add_f32 v198, v198, v199
    v_add_f32 v192, v192, v194
    v_add_f32 v196, v196, v198
    v_add_f32 v192, v192, v196
    v_mov_b32 v202, v192
    s_nop 1
    v_permlane16_swap_b32 v192, v202
    v_add_f32 v192, v192, v202
    v_mov_b32 v202, v192
    s_nop 1
    v_permlane32_swap_b32 v192, v202
    v_add_f32 v192, v192, v202
    s_mov_b32 exec_lo, 0x101
    s_mov_b32 exec_hi, 0x0
    ds_write_b32 v14, v192 offset:5248
    s_mov_b64 exec, -1
    s_waitcnt vmcnt(7)
    v_mfma_f32_16x16x32_bf16 v[196:199], v[80:83], v[112:115], 0
    s_waitcnt vmcnt(6)
    v_mfma_f32_16x16x32_bf16 v[196:199], v[84:87], v[116:119], v[196:199]
    s_waitcnt vmcnt(5)
    v_mfma_f32_16x16x32_bf16 v[196:199], v[88:91], v[120:123], v[196:199]
    s_waitcnt vmcnt(4)
    v_mfma_f32_16x16x32_bf16 v[196:199], v[92:95], v[124:127], v[196:199]
    s_waitcnt vmcnt(3)
    v_mfma_f32_16x16x32_bf16 v[196:199], v[96:99], v[128:131], v[196:199]
    s_waitcnt vmcnt(2)
    v_mfma_f32_16x16x32_bf16 v[196:199], v[100:103], v[132:135], v[196:199]
    s_waitcnt vmcnt(1)
    v_mfma_f32_16x16x32_bf16 v[196:199], v[104:107], v[136:139], v[196:199]
    s_waitcnt vmcnt(0)
    v_mfma_f32_16x16x32_bf16 v[196:199], v[108:111], v[140:143], v[196:199]
    s_nop 7
    ds_write_b128 v243, v[196:199]
    s_waitcnt lgkmcnt(0)
    s_barrier
    s_cmp_lg_u32 s3, 0
    s_cbranch_scc1 L_y7_14
    ds_read_b128 v[80:83], v20 offset:8192
    ds_read_b128 v[84:87], v20 offset:9216
    ds_read_b128 v[88:91], v20 offset:10240
    ds_read_b128 v[92:95], v20 offset:11264
    ds_read_b128 v[96:99], v20 offset:12288
    ds_read_b128 v[100:103], v20 offset:13312
    ds_read_b128 v[104:107], v20 offset:14336
    ds_read_b128 v[108:111], v20 offset:15360
    ds_read_b128 v[204:207], v244 offset:5120
    ds_read_b128 v[208:211], v244 offset:5136
    ds_read_b128 v[212:215], v244 offset:5248
    ds_read_b128 v[216:219], v244 offset:5264
    s_mov_b32 s6, 0xaaaaaaaa
    s_mov_b32 s7, 0xaaaaaaaa
    v_mov_b32 v223, v9
    s_waitcnt lgkmcnt(10)
    v_add_f32 v80, v80, v84
    v_add_f32 v81, v81, v85
    v_add_f32 v82, v82, v86
    v_add_f32 v83, v83, v87
    s_waitcnt lgkmcnt(8)
    v_add_f32 v88, v88, v92
    v_add_f32 v89, v89, v93
    v_add_f32 v90, v90, v94
    v_add_f32 v91, v91, v95
    v_add_f32 v80, v80, v88
    v_add_f32 v81, v81, v89
    v_add_f32 v82, v82, v90
    v_add_f32 v83, v83, v91
    s_waitcnt lgkmcnt(6)
    v_add_f32 v96, v96, v100
    v_add_f32 v97, v97, v101
    v_add_f32 v98, v98, v102
    v_add_f32 v99, v99, v103
    s_waitcnt lgkmcnt(4)
    v_add_f32 v104, v104, v108
    v_add_f32 v105, v105, v109
    v_add_f32 v106, v106, v110
    v_add_f32 v107, v107, v111
    v_add_f32 v96, v96, v104
    v_add_f32 v97, v97, v105
    v_add_f32 v98, v98, v106
    v_add_f32 v99, v99, v107
    v_add_f32 v80, v80, v96
    v_add_f32 v81, v81, v97
    v_add_f32 v82, v82, v98
    v_add_f32 v83, v83, v99
    v_cvt_pk_bf16_f32 v220, v80, v81
    v_cvt_pk_bf16_f32 v221, v82, v83
    s_waitcnt lgkmcnt(0)
    v_max3_f32 v204, v204, v205, v206
    v_add_f32 v212, v212, v213
    v_max3_f32 v207, v207, v208, v209
    v_add_f32 v214, v214, v215
    v_max3_f32 v204, v204, v210, v211
    v_add_f32 v216, v216, v217
    v_add_f32 v218, v218, v219
    v_max_f32 v204, v204, v207
    v_add_f32 v212, v212, v214
    v_add_f32 v216, v216, v218
    v_mul_f32 v204, s14, v204
    v_add_f32 v212, v212, v216
    v_cndmask_b32 v222, v204, v212, s[6:7]
    s_cmp_lg_u32 s101, 0
    s_cbranch_scc1 L_gs_15
    global_store_dwordx4 v19, v[220:223], s[60:61] sc1
    s_branch L_gs_16
L_gs_15:
    global_store_dwordx4 v19, v[220:223], s[60:61]
L_gs_16:
    s_mov_b32 s6, 0xff00ff00
    s_mov_b32 s7, 0xff00ff00
L_y7_14:
    s_barrier
    global_load_dwordx4 v[144:147], v16, s[56:57] offset:0 nt
    global_load_dwordx4 v[148:151], v16, s[56:57] offset:1152 nt
    s_cmp_lg_u32 s3, 7
    s_cbranch_scc1 L_y6_17
    global_load_dwordx4 v[160:163], v15, s[56:57] offset:0 nt
    global_load_dwordx4 v[164:167], v15, s[56:57] offset:1152 nt
L_y6_17:
    global_load_dwordx4 v[152:155], v16, s[56:57] offset:2304 nt
    global_load_dwordx4 v[156:159], v16, s[56:57] offset:3456 nt
    s_cmp_lg_u32 s3, 7
    s_cbranch_scc1 L_y6_18
    global_load_dwordx4 v[168:171], v15, s[56:57] offset:2304 nt
    global_load_dwordx4 v[172:175], v15, s[56:57] offset:3456 nt
L_y6_18:
    s_cmp_lg_u32 s3, 0
    s_cbranch_scc1 L_y8_19
    s_cmp_lg_u32 s101, 0
    s_cbranch_scc1 L_gd_20
    s_waitcnt vmcnt(4)
L_gd_20:
    global_load_dwordx4 v[204:207], v242, s[60:61] sc1
    s_mov_b32 s5, 0
    s_waitcnt vmcnt(0)
    v_cmp_ne_u32 vcc, v9, v207
    s_nop 1
    s_and_b64 exec, vcc, vcc
    s_cbranch_scc0 L_h3bok_22
L_h3b_21:
    global_load_dwordx4 v[204:207], v242, s[60:61] sc1
    s_add_u32 s5, s5, 1
    s_cmp_ge_u32 s5, 1000000
    s_cbranch_scc1 L_bail
    s_waitcnt vmcnt(0)
    v_cmp_ne_u32 vcc, v9, v207
    s_nop 1
    s_and_b64 exec, vcc, vcc
    s_cbranch_scc1 L_h3b_21
L_h3bok_22:
    s_mov_b64 exec, -1
    s_nop 0
    v_mov_b32_dpp v208, v206 row_ror:8 row_mask:0xf bank_mask:0xf
    v_lshlrev_b32 v212, 16, v204
    v_and_b32 v213, 0xffff0000, v204
    v_cndmask_b32 v209, v206, v208, s[6:7]
    v_cndmask_b32 v210, v208, v206, s[6:7]
    v_lshlrev_b32 v214, 16, v205
    v_mov_b32 v211, v209
    v_and_b32 v215, 0xffff0000, v205
    s_nop 0
    v_max_f32_dpp v211, v211, v211 quad_perm:[1,0,3,2] row_mask:0xf bank_mask:0xf
    s_nop 1
    v_max_f32_dpp v211, v211, v211 quad_perm:[2,3,0,1] row_mask:0xf bank_mask:0xf
    s_nop 1
    v_max_f32_dpp v211, v211, v211 row_half_mirror row_mask:0xf bank_mask:0xf
    v_sub_f32 v209, v209, v211
    v_exp_f32 v209, v209
    s_nop 0
    v_mul_f32 v216, v209, v210
    v_mul_f32 v212, v209, v212
    v_mul_f32 v213, v209, v213
    v_mul_f32 v214, v209, v214
    v_mul_f32 v215, v209, v215
    v_add_f32_dpp v216, v216, v216 quad_perm:[1,0,3,2] row_mask:0xf bank_mask:0xf
    v_add_f32_dpp v212, v212, v212 quad_perm:[1,0,3,2] row_mask:0xf bank_mask:0xf
    v_add_f32_dpp v213, v213, v213 quad_perm:[1,0,3,2] row_mask:0xf bank_mask:0xf
    v_add_f32_dpp v214, v214, v214 quad_perm:[1,0,3,2] row_mask:0xf bank_mask:0xf
    v_add_f32_dpp v215, v215, v215 quad_perm:[1,0,3,2] row_mask:0xf bank_mask:0xf
    v_add_f32_dpp v216, v216, v216 quad_perm:[2,3,0,1] row_mask:0xf bank_mask:0xf
    v_add_f32_dpp v212, v212, v212 quad_perm:[2,3,0,1] row_mask:0xf bank_mask:0xf
    v_add_f32_dpp v213, v213, v213 quad_perm:[2,3,0,1] row_mask:0xf bank_mask:0xf
    v_add_f32_dpp v214, v214, v214 quad_perm:[2,3,0,1] row_mask:0xf bank_mask:0xf
    v_add_f32_dpp v215, v215, v215 quad_perm:[2,3,0,1] row_mask:0xf bank_mask:0xf
    v_add_f32_dpp v216, v216, v216 row_half_mirror row_mask:0xf bank_mask:0xf
    v_add_f32_dpp v212, v212, v212 row_half_mirror row_mask:0xf bank_mask:0xf
    v_add_f32_dpp v213, v213, v213 row_half_mirror row_mask:0xf bank_mask:0xf
    v_add_f32_dpp v214, v214, v214 row_half_mirror row_mask:0xf bank_mask:0xf
    v_add_f32_dpp v215, v215, v215 row_half_mirror row_mask:0xf bank_mask:0xf
    v_rcp_f32 v216, v216
    s_nop 0
    v_mul_f32 v212, v216, v212
    v_mul_f32 v213, v216, v213
    v_mul_f32 v214, v216, v214
    v_mul_f32 v215, v216, v215
    ds_write_b128 v20, v[212:215] offset:5376
    s_waitcnt lgkmcnt(0)
L_y8_19:
    s_barrier
    ds_read_b128 v[212:215], v20 offset:5376
    s_waitcnt lgkmcnt(0)
    v_cvt_pk_bf16_f32 v48, v212, v212
    v_cvt_pk_bf16_f32 v49, v213, v213
    v_cvt_pk_bf16_f32 v50, v214, v214
    v_cvt_pk_bf16_f32 v51, v215, v215
    v_and_b32 v176, v48, v5
    v_and_b32 v177, v48, v6
    v_and_b32 v178, v48, v7
    v_and_b32 v179, v48, v8
    v_and_b32 v180, v49, v5
    v_and_b32 v181, v49, v6
    v_and_b32 v182, v49, v7
    v_and_b32 v183, v49, v8
    v_and_b32 v184, v50, v5
    v_and_b32 v185, v50, v6
    v_and_b32 v186, v50, v7
    v_and_b32 v187, v50, v8
    v_and_b32 v188, v51, v5
    v_and_b32 v189, v51, v6
    v_and_b32 v190, v51, v7
    v_and_b32 v191, v51, v8
    s_waitcnt vmcnt(0)
    s_cmp_eq_u32 s3, 7
    s_cbranch_scc1 L_c2b8_23
    v_mfma_f32_16x16x32_bf16 v[40:43], v[176:179], v[144:147], 0
    v_mfma_f32_16x16x32_bf16 v[40:43], v[180:183], v[148:151], v[40:43]
    v_mfma_f32_16x16x32_bf16 v[40:43], v[184:187], v[152:155], v[40:43]
    v_mfma_f32_16x16x32_bf16 v[40:43], v[188:191], v[156:159], v[40:43]
    s_nop 7
    v_permlane32_swap_b32 v40, v42
    v_permlane32_swap_b32 v41, v43
    s_nop 0
    v_add_f32_dpp v40, v42, v40 row_ror:8 row_mask:0xf bank_mask:0xf
    v_add_f32_dpp v41, v43, v41 row_ror:8 row_mask:0xf bank_mask:0xf
    v_cvt_pk_bf16_f32 v40, v40, v41
    v_mov_b32 v41, v9
    s_mov_b32 exec_lo, 0xff00ff
    s_mov_b32 exec_hi, 0xff00ff
    global_store_dwordx2 v240, v[40:41], s[60:61] sc1
    s_branch L_c2e_24
L_c2b8_23:
    v_mfma_f32_16x16x32_bf16 v[40:43], v[176:179], v[144:147], 0
    v_mfma_f32_16x16x32_bf16 v[44:47], v[176:179], v[160:163], 0
    v_mfma_f32_16x16x32_bf16 v[40:43], v[180:183], v[148:151], v[40:43]
    v_mfma_f32_16x16x32_bf16 v[44:47], v[180:183], v[164:167], v[44:47]
    v_mfma_f32_16x16x32_bf16 v[40:43], v[184:187], v[152:155], v[40:43]
    v_mfma_f32_16x16x32_bf16 v[44:47], v[184:187], v[168:171], v[44:47]
    v_mfma_f32_16x16x32_bf16 v[40:43], v[188:191], v[156:159], v[40:43]
    v_mfma_f32_16x16x32_bf16 v[44:47], v[188:191], v[172:175], v[44:47]
    s_nop 6
    v_permlane32_swap_b32 v40, v42
    v_permlane32_swap_b32 v41, v43
    v_permlane32_swap_b32 v44, v46
    v_permlane32_swap_b32 v45, v47
    v_add_f32_dpp v40, v42, v40 row_ror:8 row_mask:0xf bank_mask:0xf
    v_add_f32_dpp v41, v43, v41 row_ror:8 row_mask:0xf bank_mask:0xf
    v_add_f32_dpp v44, v46, v44 row_ror:8 row_mask:0xf bank_mask:0xf
    v_add_f32_dpp v45, v47, v45 row_ror:8 row_mask:0xf bank_mask:0xf
    v_cvt_pk_bf16_f32 v40, v40, v41
    v_mov_b32 v41, v9
    v_cvt_pk_bf16_f32 v44, v44, v45
    v_mov_b32 v45, v9
    s_mov_b32 exec_lo, 0xff00ff
    s_mov_b32 exec_hi, 0xff00ff
    global_store_dwordx2 v240, v[40:41], s[60:61] sc1
    global_store_dwordx2 v241, v[44:45], s[60:61] sc1
L_c2e_24:
    s_mov_b64 exec, -1
    s_branch L_end
L_X0:
    s_and_b32 s12, s4, 1
    s_lshr_b32 s13, s4, 1
    s_lshl_b32 s6, s13, 17
    s_lshl_b32 s14, s3, 14
    s_add_u32 s6, s6, s14
    v_add_u32 v10, s6, v20
    s_mul_i32 s6, s12, 8208
    v_xor_b32 v10, s6, v10
    s_and_b32 s6, s6, 0x2000
    s_add_u32 s15, s14, s6
    s_xor_b32 s16, s15, 0x2000
    s_waitcnt lgkmcnt(0)
    s_add_u32 m0, s15, 0
    v_xor_b32 v11, 0x0, v10
    global_load_lds_dwordx4 v11, s[38:39] offset:0
    s_load_dword s62, s[60:61], 0
    v_lshlrev_b32 v16, 1, v3
    v_lshrrev_b32 v17, 3, v1
    v_or_b32 v16, v16, v17
    v_lshlrev_b32 v17, 2, v2
    v_xor_b32 v16, v16, v17
    v_lshlrev_b32 v16, 4, v16
    v_lshl_add_u32 v16, v1, 10, v16
    v_add_u32 v12, s14, v16
    v_xor_b32 v13, 0x10, v12
    v_xor_b32 v14, 0x20, v12
    v_xor_b32 v15, 0x30, v12
    v_bfe_u32 v21, v0, 2, 2
    v_and_b32 v26, 1, v2
    v_lshrrev_b32 v27, 1, v2
    v_lshl_add_u32 v21, v26, 2, v21
    v_lshl_add_u32 v22, v27, 4, v21
    v_lshlrev_b32 v21, 1, v21
    v_bfe_u32 v23, v0, 1, 1
    s_lshl_b32 s6, s3, 3
    v_add_u32 v23, s6, v23
    v_xor_b32 v23, v23, v21
    v_lshlrev_b32 v23, 4, v23
    v_lshl_add_u32 v23, v22, 10, v23
    v_and_b32 v21, 1, v0
    v_lshl_add_u32 v18, v21, 3, v23
    s_lshl_b32 s6, s12, 15
    s_lshl_b32 s7, s3, 12
    s_add_u32 s6, s6, s7
    s_add_u32 s6, s6, 327680
    v_lshlrev_b32 v25, 4, v3
    v_lshl_add_u32 v30, v4, 9, v25
    v_add_u32 v30, s6, v30
    v_lshrrev_b32 v28, 5, v0
    s_lshl_b32 s6, s3, 1
    v_add_u32 v28, s6, v28
    v_and_b32 v22, 7, v28
    v_lshlrev_b32 v22, 1, v22
    v_lshrrev_b32 v23, 3, v28
    v_or_b32 v22, v22, v23
    v_and_b32 v23, 3, v4
    v_lshlrev_b32 v23, 4, v23
    v_bfe_u32 v24, v0, 1, 2
    v_or_b32 v23, v23, v24
    v_xor_b32 v23, v23, v22
    v_lshlrev_b32 v23, 4, v23
    v_lshl_add_u32 v28, v28, 10, v23
    v_lshl_add_u32 v28, v21, 3, v28
    v_add_u32 v192, 131072, v28
    v_xor_b32 v193, 0x40, v192
    v_xor_b32 v194, 0x80, v192
    v_xor_b32 v195, 0xc0, v192
    v_lshlrev_b32 v196, 5, v1
    v_add_u32 v196, 151552, v196
    s_lshl_b32 s6, s3, 2
    v_add_u32 v197, s6, v196
    s_lshr_b32 s6, s3, 1
    s_lshl_b32 s6, s6, 10
    s_and_b32 s7, s3, 1
    s_lshl_b32 s7, s7, 9
    s_add_u32 s6, s6, s7
    s_add_u32 s6, s6, 147456
    v_lshlrev_b32 v198, 8, v26
    v_lshl_add_u32 v198, v1, 4, v198
    v_lshl_add_u32 v198, v27, 3, v198
    v_add_u32 v198, s6, v198
    v_lshlrev_b32 v199, 2, v1
    v_add_u32 v199, 152064, v199
    v_add_u32 v203, 147456, v20
    v_lshrrev_b32 v204, 2, v3
    v_lshl_add_u32 v204, v21, 1, v204
    v_lshl_add_u32 v204, v2, 2, v204
    v_lshlrev_b32 v204, 2, v204
    v_mul_u32_u24 v219, 36, v204
    v_add_u32 v219, 152576, v219
    v_add_u32 v204, 152064, v204
    s_lshl_b32 s6, s3, 4
    s_add_u32 s6, s6, 152576
    v_mul_u32_u24 v218, 144, v1
    v_lshl_add_u32 v218, v2, 2, v218
    v_add_u32 v218, s6, v218
    s_lshl_b32 s6, s12, 6
    s_lshl_b32 s7, s3, 1
    s_add_u32 s6, s6, s7
    v_lshrrev_b32 v29, 3, v1
    v_lshl_add_u32 v29, v2, 4, v29
    v_add_u32 v29, s6, v29
    v_mul_u32_u24 v240, 24576, v29
    s_mul_i32 s6, s13, 384
    s_add_u32 s6, s6, 2101248
    v_add3_u32 v240, s6, v240, v25
    s_lshr_b32 s6, s13, 3
    s_lshl_b32 s6, s6, 7
    s_and_b32 s7, s13, 7
    s_lshl_b32 s7, s7, 2
    s_add_u32 s6, s6, s7
    s_add_u32 s6, s6, 1703936
    v_lshl_add_u32 v241, v29, 10, s6
    s_lshl_b32 s6, s4, 10
    s_lshl_b32 s7, s3, 7
    s_add_u32 s6, s6, s7
    s_add_u32 s6, s6, 393216
    s_add_u32 s24, s60, s6
    s_addc_u32 s25, s61, 0
    s_add_u32 s26, s24, 1310720
    s_addc_u32 s27, s25, 0
    v_and_b32 v200, 1, v0
    v_lshlrev_b32 v200, 4, v200
    v_mov_b32 v202, 0xffff
    v_lshlrev_b32 v200, v200, v202
    s_mov_b32 s6, 0x3030303
    s_mov_b32 s7, 0x3030303
    v_cndmask_b32 v5, 0, v200, s[6:7]
    s_mov_b32 s6, 0xc0c0c0c
    s_mov_b32 s7, 0xc0c0c0c
    v_cndmask_b32 v6, 0, v200, s[6:7]
    s_mov_b32 s6, 0x30303030
    s_mov_b32 s7, 0x30303030
    v_cndmask_b32 v7, 0, v200, s[6:7]
    s_mov_b32 s6, 0xc0c0c0c0
    s_mov_b32 s7, 0xc0c0c0c0
    v_cndmask_b32 v8, 0, v200, s[6:7]
    s_waitcnt lgkmcnt(0)
    s_add_u32 s62, s62, 1
    s_mul_i32 s63, s62, 0x9E3779B1
    s_and_b32 s63, s63, 0xBFFFBFFF
    v_mov_b32 v9, s63
    s_mov_b32 s18, s63
    s_mov_b32 s19, s63
    s_waitcnt vmcnt(0)
    v_xor_b32 v11, 0x20, v10
    global_load_lds_dwordx4 v11, s[38:39] offset:1024
    s_lshr_b32 s20, s4, 4
    s_and_b32 s21, s4, 15
    s_lshr_b32 s6, s21, 1
    s_lshl_b32 s6, s6, 6
    s_and_b32 s7, s21, 1
    s_lshl_b32 s7, s7, 3
    s_add_u32 s6, s6, s7
    v_add_u32 v246, s6, v4
    v_lshlrev_b32 v246, 13, v246
    s_lshl_b32 s6, s20, 10
    s_lshl_b32 s7, s3, 7
    s_add_u32 s6, s6, s7
    v_add3_u32 v246, s6, v246, v25
    s_lshl_b32 s6, s20, 4
    s_lshl_b32 s7, s3, 1
    s_add_u32 s6, s6, s7
    s_lshl_b32 s6, s6, 11
    s_lshl_b32 s7, s21, 7
    s_add_u32 s6, s6, s7
    s_add_u32 s6, s6, 524288
    v_lshlrev_b32 v242, 11, v26
    v_lshl_add_u32 v242, v27, 6, v242
    v_lshl_add_u32 v242, v1, 3, v242
    v_add_u32 v242, s6, v242
    s_lshr_b32 s6, s4, 1
    s_lshl_b32 s6, s6, 6
    s_and_b32 s7, s4, 1
    s_lshl_b32 s7, s7, 2
    s_add_u32 s6, s6, s7
    v_and_b32 v247, 3, v4
    v_lshlrev_b32 v247, 4, v247
    v_lshrrev_b32 v24, 2, v4
    v_lshl_add_u32 v247, v24, 1, v247
    v_add_u32 v247, s6, v247
    v_mul_u32_u24 v247, 1152, v247
    v_add_u32 v247, v25, v247
    s_lshl_b32 s6, s3, 7
    v_add_u32 v245, s6, v247
    v_add_u32 v247, 0x400, v247
    s_mul_i32 s6, s4, 24576
    s_mul_i32 s7, s3, 3072
    s_add_u32 s6, s6, s7
    s_add_u32 s6, s6, 2101248
    v_mul_u32_u24 v205, 384, v4
    v_add3_u32 v205, s6, v205, v25
    s_lshl_b32 s6, s3, 10
    v_lshlrev_b32 v206, 8, v26
    v_lshl_add_u32 v206, v27, 7, v206
    v_add3_u32 v206, s6, v206, v25
    s_lshl_b32 s6, s3, 3
    v_add_u32 v207, s6, v20
    v_mov_b32 v208, 0x3f803f80
    v_mov_b32 v209, 0x3f803f80
    v_mov_b32 v210, 0x3f803f80
    v_mov_b32 v211, 0x3f803f80
    s_lshr_b32 s22, s3, 1
    s_lshl_b32 s6, s22, 8
    v_lshlrev_b32 v212, 10, v3
    v_lshl_add_u32 v212, v4, 4, v212
    v_add_u32 v212, s6, v212
    s_lshl_b32 s6, s22, 6
    v_lshl_add_u32 v213, v3, 3, s6
    s_lshl_b32 s6, s4, 11
    s_add_u32 s6, s6, 524288
    v_lshlrev_b32 v214, 7, v3
    v_lshl_add_u32 v214, v4, 4, v214
    v_add_u32 v214, s6, v214
    s_lshl_b32 s6, s4, 14
    s_and_b32 s8, s3, 1
    s_lshl_b32 s7, s8, 6
    s_add_u32 s6, s6, s7
    s_add_u32 s6, s6, 1052672
    v_lshrrev_b32 v215, 2, v0
    v_lshlrev_b32 v215, 7, v215
    v_and_b32 v24, 3, v0
    v_lshl_add_u32 v215, v24, 4, v215
    v_add_u32 v215, s6, v215
    v_add_u32 v216, 0x2000, v215
    s_cmp_ge_u32 s4, 18
    s_cselect_b32 s6, 18, 0
    s_cselect_b32 s7, 576, 0
    s_sub_u32 s6, s4, s6
    s_lshr_b32 s9, s6, 1
    s_lshl_b32 s9, s9, 6
    s_add_u32 s7, s7, s9
    s_and_b32 s9, s6, 1
    s_lshl_b32 s9, s9, 1
    s_add_u32 s9, s9, s8
    s_lshl_b32 s9, s9, 1
    s_add_u32 s7, s7, s9
    s_lshl_b32 s7, s7, 1
    v_lshlrev_b32 v217, 5, v1
    v_lshl_add_u32 v217, v2, 4, v217
    v_add_u32 v217, s7, v217
    s_lshl_b32 s6, s3, 15
    s_lshl_b32 s7, s4, 7
    s_add_u32 s6, s6, s7
    s_add_u32 s6, s6, 1048576
    v_and_b32 v243, 1, v2
    v_lshlrev_b32 v243, 14, v243
    v_lshrrev_b32 v244, 1, v2
    v_lshl_add_u32 v243, v244, 6, v243
    v_lshl_add_u32 v243, v1, 3, v243
    v_add_u32 v243, s6, v243
    v_add_u32 v244, 0x8000, v243
    s_getreg_b32 s31, hwreg(HW_REG_XCC_ID, 0, 4)
    s_lshl_b32 s31, s31, 4
    s_xor_b32 s31, s31, s63
    s_lshr_b32 s30, s4, 4
    s_lshl_b32 s30, s30, 7
    s_add_u32 s30, s30, 5120
    s_cmp_lg_u32 s3, 7
    s_cbranch_scc1 L_dp_25
    s_and_b32 s6, s4, 15
    s_lshl_b32 s6, s6, 2
    s_add_u32 s6, s6, s30
    v_mov_b32 v200, s6
    v_mov_b32 v202, s31
    s_mov_b64 exec, 1
    global_store_dword v200, v202, s[60:61] sc1
    s_mov_b64 exec, -1
L_dp_25:
    s_waitcnt vmcnt(0)
    v_xor_b32 v11, 0x40, v10
    global_load_lds_dwordx4 v11, s[38:39] offset:2048
    s_waitcnt vmcnt(0)
    v_xor_b32 v11, 0x60, v10
    global_load_lds_dwordx4 v11, s[38:39] offset:3072
    s_add_u32 m0, s15, 4096
    v_xor_b32 v11, 0x1080, v10
    global_load_lds_dwordx4 v11, s[38:39] offset:0
    v_xor_b32 v11, 0x10a0, v10
    global_load_lds_dwordx4 v11, s[38:39] offset:1024
    s_waitcnt vmcnt(2)
    v_xor_b32 v11, 0x10c0, v10
    global_load_lds_dwordx4 v11, s[38:39] offset:2048
    v_xor_b32 v11, 0x10e0, v10
    global_load_lds_dwordx4 v11, s[38:39] offset:3072
    s_add_u32 m0, s16, 0
    v_xor_b32 v11, 0x2010, v10
    global_load_lds_dwordx4 v11, s[38:39] offset:0
    s_lshl_b32 s6, s3, 15
    s_lshl_b32 s7, s4, 7
    s_add_u32 s6, s6, s7
    s_add_u32 s6, s6, 1048576
    s_add_u32 s6, s60, s6
    s_addc_u32 s7, s61, 0
    s_load_dword s100, s[6:7], 0
    s_load_dword s100, s[6:7], 64
    s_load_dword s100, s[6:7], 16384
    s_load_dword s100, s[6:7], 16448
    s_cmp_lg_u32 s3, 7
    s_cbranch_scc1 L_wl_26
    s_load_dword s100, s[6:7], 32768
    s_load_dword s100, s[6:7], 32832
    s_load_dword s100, s[6:7], 49152
    s_load_dword s100, s[6:7], 49216
L_wl_26:
    s_lshl_b32 s6, s20, 4
    s_lshl_b32 s7, s3, 1
    s_add_u32 s6, s6, s7
    s_lshl_b32 s6, s6, 11
    s_lshl_b32 s7, s21, 7
    s_add_u32 s6, s6, s7
    s_add_u32 s6, s6, 524288
    s_add_u32 s6, s60, s6
    s_addc_u32 s7, s61, 0
    s_load_dword s100, s[6:7], 0
    s_load_dword s100, s[6:7], 64
    s_load_dword s100, s[6:7], 2048
    s_load_dword s100, s[6:7], 2112
    s_waitcnt vmcnt(4)
    v_xor_b32 v11, 0x2030, v10
    global_load_lds_dwordx4 v11, s[38:39] offset:1024
    s_waitcnt vmcnt(4)
    v_xor_b32 v11, 0x2050, v10
    global_load_lds_dwordx4 v11, s[38:39] offset:2048
    s_waitcnt vmcnt(4)
    v_xor_b32 v11, 0x2070, v10
    global_load_lds_dwordx4 v11, s[38:39] offset:3072
    s_waitcnt vmcnt(4)
    s_add_u32 m0, s16, 4096
    v_xor_b32 v11, 0x3090, v10
    global_load_lds_dwordx4 v11, s[38:39] offset:0
    s_waitcnt vmcnt(4)
    v_xor_b32 v11, 0x30b0, v10
    global_load_lds_dwordx4 v11, s[38:39] offset:1024
    v_xor_b32 v11, 0x30d0, v10
    global_load_lds_dwordx4 v11, s[38:39] offset:2048
    v_xor_b32 v11, 0x30f0, v10
    global_load_lds_dwordx4 v11, s[38:39] offset:3072
    s_mov_b32 s23, 0
    s_mov_b64 s[32:33], -1
    s_add_u32 s6, s60, s30
    s_addc_u32 s7, s61, 0
    s_load_dwordx8 s[64:71], s[6:7], 0
    s_load_dwordx8 s[48:55], s[6:7], 32
    s_waitcnt vmcnt(0)
    s_waitcnt lgkmcnt(0)
    s_mov_b32 s6, s31
    s_mov_b32 s7, s31
    s_xor_b64 s[64:65], s[64:65], s[6:7]
    s_xor_b64 s[66:67], s[66:67], s[6:7]
    s_xor_b64 s[68:69], s[68:69], s[6:7]
    s_xor_b64 s[70:71], s[70:71], s[6:7]
    s_xor_b64 s[48:49], s[48:49], s[6:7]
    s_xor_b64 s[50:51], s[50:51], s[6:7]
    s_xor_b64 s[52:53], s[52:53], s[6:7]
    s_xor_b64 s[54:55], s[54:55], s[6:7]
    s_or_b64 s[64:65], s[64:65], s[66:67]
    s_or_b64 s[64:65], s[64:65], s[68:69]
    s_or_b64 s[64:65], s[64:65], s[70:71]
    s_or_b64 s[64:65], s[64:65], s[48:49]
    s_or_b64 s[64:65], s[64:65], s[50:51]
    s_or_b64 s[64:65], s[64:65], s[52:53]
    s_or_b64 s[64:65], s[64:65], s[54:55]
    s_cselect_b32 s101, 0, 1
    ds_read_b128 v[32:35], v12 offset:0
    ds_read_b128 v[36:39], v13 offset:0
    ds_read_b128 v[40:43], v14 offset:0
    ds_read_b128 v[44:47], v15 offset:0
    ds_read_b128 v[48:51], v12 offset:256
    ds_read_b128 v[52:55], v13 offset:256
    ds_read_b128 v[56:59], v14 offset:256
    ds_read_b128 v[60:63], v15 offset:256
    s_waitcnt lgkmcnt(4)
    ds_read_b128 v[64:67], v12 offset:512
    ds_read_b128 v[68:71], v13 offset:512
    ds_read_b128 v[72:75], v14 offset:512
    ds_read_b128 v[76:79], v15 offset:512
    ds_read_b128 v[80:83], v12 offset:768
    ds_read_b128 v[84:87], v13 offset:768
    ds_read_b128 v[88:91], v14 offset:768
    ds_read_b128 v[92:95], v15 offset:768
    s_waitcnt lgkmcnt(6)
    s_barrier
    global_load_dwordx4 v[160:163], v30, s[60:61] offset:0 sc1
    global_load_dwordx4 v[164:167], v30, s[60:61] offset:128 sc1
    global_load_dwordx4 v[168:171], v30, s[60:61] offset:256 sc1
    global_load_dwordx4 v[172:175], v30, s[60:61] offset:384 sc1
    v_xor_b32 v19, 0x0, v18
    ds_read_b64_tr_b16 v[96:97], v19 offset:0
    ds_read_b64_tr_b16 v[112:113], v19 offset:32768
    v_xor_b32 v19, 0x10, v18
    ds_read_b64_tr_b16 v[98:99], v19 offset:8192
    ds_read_b64_tr_b16 v[114:115], v19 offset:40960
    v_xor_b32 v19, 0x20, v18
    ds_read_b64_tr_b16 v[100:101], v19 offset:0
    ds_read_b64_tr_b16 v[116:117], v19 offset:32768
    v_xor_b32 v19, 0x30, v18
    ds_read_b64_tr_b16 v[102:103], v19 offset:8192
    ds_read_b64_tr_b16 v[118:119], v19 offset:40960
    s_waitcnt lgkmcnt(4)
    v_xor_b32 v19, 0x40, v18
    ds_read_b64_tr_b16 v[104:105], v19 offset:0
    ds_read_b64_tr_b16 v[120:121], v19 offset:32768
    v_xor_b32 v19, 0x50, v18
    ds_read_b64_tr_b16 v[106:107], v19 offset:8192
    ds_read_b64_tr_b16 v[122:123], v19 offset:40960
    v_xor_b32 v19, 0x60, v18
    ds_read_b64_tr_b16 v[108:109], v19 offset:0
    ds_read_b64_tr_b16 v[124:125], v19 offset:32768
    v_xor_b32 v19, 0x70, v18
    ds_read_b64_tr_b16 v[110:111], v19 offset:8192
    ds_read_b64_tr_b16 v[126:127], v19 offset:40960
    s_waitcnt lgkmcnt(6)
    v_add_u32 v18, 0x10000, v18
    v_xor_b32 v19, 0x0, v18
    ds_read_b64_tr_b16 v[128:129], v19 offset:0
    ds_read_b64_tr_b16 v[144:145], v19 offset:32768
    v_xor_b32 v19, 0x10, v18
    ds_read_b64_tr_b16 v[130:131], v19 offset:8192
    ds_read_b64_tr_b16 v[146:147], v19 offset:40960
    v_xor_b32 v19, 0x20, v18
    ds_read_b64_tr_b16 v[132:133], v19 offset:0
    ds_read_b64_tr_b16 v[148:149], v19 offset:32768
    v_xor_b32 v19, 0x30, v18
    ds_read_b64_tr_b16 v[134:135], v19 offset:8192
    ds_read_b64_tr_b16 v[150:151], v19 offset:40960
    s_waitcnt lgkmcnt(6)
    v_xor_b32 v19, 0x40, v18
    ds_read_b64_tr_b16 v[136:137], v19 offset:0
    ds_read_b64_tr_b16 v[152:153], v19 offset:32768
    v_xor_b32 v19, 0x50, v18
    ds_read_b64_tr_b16 v[138:139], v19 offset:8192
    ds_read_b64_tr_b16 v[154:155], v19 offset:40960
    v_xor_b32 v19, 0x60, v18
    ds_read_b64_tr_b16 v[140:141], v19 offset:0
    ds_read_b64_tr_b16 v[156:157], v19 offset:32768
    v_xor_b32 v19, 0x70, v18
    ds_read_b64_tr_b16 v[142:143], v19 offset:8192
    ds_read_b64_tr_b16 v[158:159], v19 offset:40960
    s_sub_u32 s6, 131072, s14
    v_add_u32 v12, s6, v12
    v_add_u32 v13, s6, v13
    v_add_u32 v14, s6, v14
    v_add_u32 v15, s6, v15
    s_mov_b32 s5, 0
    s_waitcnt vmcnt(0)
    v_xor_b32 v21, v9, v161
    v_xor_b32 v22, v9, v163
    v_bitop3_b32 v21, v165, v9, v21 bitop3:0xbe
    v_bitop3_b32 v22, v167, v9, v22 bitop3:0xbe
    v_bitop3_b32 v21, v169, v9, v21 bitop3:0xbe
    v_bitop3_b32 v22, v171, v9, v22 bitop3:0xbe
    v_bitop3_b32 v21, v173, v9, v21 bitop3:0xbe
    v_bitop3_b32 v22, v175, v9, v22 bitop3:0xbe
    v_or_b32 v21, v21, v22
    v_cmp_ne_u32 vcc, 0, v21
    s_nop 1
    s_and_b64 exec, vcc, vcc
    s_cbranch_scc0 L_h2ok_28
L_h2_27:
    global_load_dwordx4 v[160:163], v30, s[60:61] offset:0 sc1
    global_load_dwordx4 v[164:167], v30, s[60:61] offset:128 sc1
    global_load_dwordx4 v[168:171], v30, s[60:61] offset:256 sc1
    global_load_dwordx4 v[172:175], v30, s[60:61] offset:384 sc1
    s_add_u32 s5, s5, 1
    s_cmp_ge_u32 s5, 1000000
    s_cbranch_scc1 L_bail
    s_waitcnt vmcnt(0)
    v_xor_b32 v21, v9, v161
    v_xor_b32 v22, v9, v163
    v_bitop3_b32 v21, v165, v9, v21 bitop3:0xbe
    v_bitop3_b32 v22, v167, v9, v22 bitop3:0xbe
    v_bitop3_b32 v21, v169, v9, v21 bitop3:0xbe
    v_bitop3_b32 v22, v171, v9, v22 bitop3:0xbe
    v_bitop3_b32 v21, v173, v9, v21 bitop3:0xbe
    v_bitop3_b32 v22, v175, v9, v22 bitop3:0xbe
    v_or_b32 v21, v21, v22
    v_cmp_ne_u32 vcc, 0, v21
    s_nop 1
    s_and_b64 exec, vcc, vcc
    s_cbranch_scc1 L_h2_27
L_h2ok_28:
    s_mov_b64 exec, -1
    v_mov_b32 v161, v162
    ds_write_b64 v192, v[160:161]
    v_mov_b32 v165, v166
    ds_write_b64 v193, v[164:165]
    v_mov_b32 v169, v170
    ds_write_b64 v194, v[168:169]
    v_mov_b32 v173, v174
    ds_write_b64 v195, v[172:173]
    global_load_dwordx4 v[224:227], v246, s[44:45] nt
    v_add_u32 v246, 0x20000, v246
    global_load_dwordx4 v[228:231], v246, s[44:45] nt
    v_add_u32 v246, 0x20000, v246
    global_load_dwordx4 v[232:235], v246, s[44:45] nt
    s_waitcnt lgkmcnt(0)
    s_barrier
    ds_read_b128 v[160:163], v12 offset:0
    ds_read_b128 v[164:167], v13 offset:0
    ds_read_b128 v[168:171], v14 offset:0
    ds_read_b128 v[172:175], v15 offset:0
    ds_read_b128 v[176:179], v12 offset:256
    ds_read_b128 v[180:183], v13 offset:256
    ds_read_b128 v[184:187], v14 offset:256
    ds_read_b128 v[188:191], v15 offset:256
    s_waitcnt lgkmcnt(7)
    v_mfma_f32_16x16x32_bf16 v[24:27], v[32:35], v[160:163], 0
    ds_read_b128 v[160:163], v12 offset:512
    s_waitcnt lgkmcnt(7)
    v_mfma_f32_16x16x32_bf16 v[24:27], v[36:39], v[164:167], v[24:27]
    ds_read_b128 v[164:167], v13 offset:512
    s_waitcnt lgkmcnt(7)
    v_mfma_f32_16x16x32_bf16 v[24:27], v[40:43], v[168:171], v[24:27]
    ds_read_b128 v[168:171], v14 offset:512
    s_waitcnt lgkmcnt(7)
    v_mfma_f32_16x16x32_bf16 v[24:27], v[44:47], v[172:175], v[24:27]
    ds_read_b128 v[172:175], v15 offset:512
    s_waitcnt lgkmcnt(7)
    v_mfma_f32_16x16x32_bf16 v[24:27], v[48:51], v[176:179], v[24:27]
    ds_read_b128 v[176:179], v12 offset:768
    s_waitcnt lgkmcnt(7)
    v_mfma_f32_16x16x32_bf16 v[24:27], v[52:55], v[180:183], v[24:27]
    ds_read_b128 v[180:183], v13 offset:768
    s_waitcnt lgkmcnt(7)
    v_mfma_f32_16x16x32_bf16 v[24:27], v[56:59], v[184:187], v[24:27]
    ds_read_b128 v[184:187], v14 offset:768
    s_waitcnt lgkmcnt(7)
    v_mfma_f32_16x16x32_bf16 v[24:27], v[60:63], v[188:191], v[24:27]
    ds_read_b128 v[188:191], v15 offset:768
    s_waitcnt lgkmcnt(7)
    v_mfma_f32_16x16x32_bf16 v[24:27], v[64:67], v[160:163], v[24:27]
    s_waitcnt lgkmcnt(6)
    v_mfma_f32_16x16x32_bf16 v[24:27], v[68:71], v[164:167], v[24:27]
    s_waitcnt lgkmcnt(5)
    v_mfma_f32_16x16x32_bf16 v[24:27], v[72:75], v[168:171], v[24:27]
    s_waitcnt lgkmcnt(4)
    v_mfma_f32_16x16x32_bf16 v[24:27], v[76:79], v[172:175], v[24:27]
    s_waitcnt lgkmcnt(3)
    v_mfma_f32_16x16x32_bf16 v[24:27], v[80:83], v[176:179], v[24:27]
    s_waitcnt lgkmcnt(2)
    v_mfma_f32_16x16x32_bf16 v[24:27], v[84:87], v[180:183], v[24:27]
    s_waitcnt lgkmcnt(1)
    v_mfma_f32_16x16x32_bf16 v[24:27], v[88:91], v[184:187], v[24:27]
    s_waitcnt lgkmcnt(0)
    v_mfma_f32_16x16x32_bf16 v[24:27], v[92:95], v[188:191], v[24:27]
    v_mov_b32 v55, v9
    v_mov_b32 v59, v9
    v_mov_b32 v63, v9
    s_mov_b32 s6, 0xf0f0f0f0
    s_mov_b32 s7, 0xf0f0f0f0
    s_mov_b32 s8, 0xaaaaaaaa
    s_mov_b32 s9, 0xaaaaaaaa
    s_mov_b32 s10, 0xcccccccc
    s_mov_b32 s11, 0xcccccccc
    v_max3_f32 v28, v24, v25, v26
    v_max_f32 v28, v28, v27
    v_mov_b32 v29, v28
    s_nop 1
    v_permlane16_swap_b32 v28, v29
    v_max_f32 v28, v28, v29
    v_mov_b32 v29, v28
    s_nop 1
    v_permlane32_swap_b32 v28, v29
    v_max_f32 v28, v28, v29
    ds_write_b32 v197, v28
    s_waitcnt lgkmcnt(0)
    s_barrier
    ds_read_b128 v[160:163], v196
    ds_read_b128 v[164:167], v196 offset:16
    s_waitcnt lgkmcnt(1)
    v_max3_f32 v28, v160, v161, v162
    s_waitcnt lgkmcnt(0)
    v_max3_f32 v29, v164, v165, v166
    v_max3_f32 v28, v28, v163, v167
    v_max_f32 v28, v28, v29
    v_sub_f32 v24, v24, v28
    v_sub_f32 v25, v25, v28
    v_sub_f32 v26, v26, v28
    v_sub_f32 v27, v27, v28
    v_exp_f32 v24, v24
    v_exp_f32 v25, v25
    v_exp_f32 v26, v26
    v_exp_f32 v27, v27
    ds_write_b32 v199, v28
    v_cvt_pk_bf16_f32 v28, v24, v25
    v_cvt_pk_bf16_f32 v29, v26, v27
    ds_write_b64 v198, v[28:29]
    v_add_f32 v24, v24, v25
    v_add_f32 v26, v26, v27
    v_add_f32 v24, v24, v26
    ds_write_b32 v218, v24
    s_waitcnt lgkmcnt(0)
    s_barrier
    ds_read_b128 v[160:163], v203 offset:0
    ds_read_b128 v[164:167], v203 offset:1024
    ds_read_b128 v[168:171], v203 offset:2048
    ds_read_b128 v[172:175], v203 offset:3072
    ds_read_b32 v62, v204
    ds_read_b128 v[64:67], v219 offset:0
    ds_read_b128 v[68:71], v219 offset:16
    ds_read_b128 v[72:75], v219 offset:32
    ds_read_b128 v[76:79], v219 offset:48
    ds_read_b128 v[80:83], v219 offset:64
    ds_read_b128 v[84:87], v219 offset:80
    ds_read_b128 v[88:91], v219 offset:96
    ds_read_b128 v[92:95], v219 offset:112
    s_waitcnt lgkmcnt(12)
    v_mfma_f32_16x16x32_bf16 v[32:35], v[160:163], v[96:99], 0
    v_mfma_f32_16x16x32_bf16 v[36:39], v[160:163], v[100:103], 0
    v_mfma_f32_16x16x32_bf16 v[40:43], v[160:163], v[104:107], 0
    v_mfma_f32_16x16x32_bf16 v[44:47], v[160:163], v[108:111], 0
    s_waitcnt lgkmcnt(11)
    v_mfma_f32_16x16x32_bf16 v[32:35], v[164:167], v[112:115], v[32:35]
    v_mfma_f32_16x16x32_bf16 v[36:39], v[164:167], v[116:119], v[36:39]
    v_mfma_f32_16x16x32_bf16 v[40:43], v[164:167], v[120:123], v[40:43]
    v_mfma_f32_16x16x32_bf16 v[44:47], v[164:167], v[124:127], v[44:47]
    s_waitcnt lgkmcnt(0)
    v_add_f32 v64, v64, v80
    v_add_f32 v65, v65, v81
    v_add_f32 v66, v66, v82
    v_add_f32 v67, v67, v83
    v_add_f32 v68, v68, v84
    v_add_f32 v69, v69, v85
    v_add_f32 v70, v70, v86
    v_add_f32 v71, v71, v87
    v_add_f32 v72, v72, v88
    v_add_f32 v73, v73, v89
    v_add_f32 v74, v74, v90
    v_add_f32 v75, v75, v91
    v_add_f32 v76, v76, v92
    v_add_f32 v77, v77, v93
    v_add_f32 v78, v78, v94
    v_add_f32 v79, v79, v95
    v_add_f32 v64, v64, v72
    v_add_f32 v65, v65, v73
    v_add_f32 v66, v66, v74
    v_add_f32 v67, v67, v75
    v_add_f32 v68, v68, v76
    v_add_f32 v69, v69, v77
    v_add_f32 v70, v70, v78
    v_add_f32 v71, v71, v79
    s_waitcnt lgkmcnt(10)
    v_mfma_f32_16x16x32_bf16 v[32:35], v[168:171], v[128:131], v[32:35]
    v_mfma_f32_16x16x32_bf16 v[36:39], v[168:171], v[132:135], v[36:39]
    v_mfma_f32_16x16x32_bf16 v[40:43], v[168:171], v[136:139], v[40:43]
    v_mfma_f32_16x16x32_bf16 v[44:47], v[168:171], v[140:143], v[44:47]
    v_add_f32 v64, v64, v68
    v_add_f32 v65, v65, v69
    v_add_f32 v66, v66, v70
    v_add_f32 v67, v67, v71
    v_add_f32 v64, v64, v66
    v_add_f32 v65, v65, v67
    v_add_f32 v64, v64, v65
    v_cndmask_b32 v62, v62, v64, s[10:11]
    s_waitcnt lgkmcnt(9)
    v_mfma_f32_16x16x32_bf16 v[32:35], v[172:175], v[144:147], v[32:35]
    v_mfma_f32_16x16x32_bf16 v[36:39], v[172:175], v[148:151], v[36:39]
    v_mfma_f32_16x16x32_bf16 v[40:43], v[172:175], v[152:155], v[40:43]
    v_mfma_f32_16x16x32_bf16 v[44:47], v[172:175], v[156:159], v[44:47]
    s_nop 5
    v_cvt_pk_bf16_f32 v52, v32, v36
    v_cvt_pk_bf16_f32 v54, v33, v37
    v_cvt_pk_bf16_f32 v53, v40, v44
    global_store_dwordx4 v240, v[52:55], s[60:61] sc1
    v_cvt_pk_bf16_f32 v56, v34, v38
    v_cvt_pk_bf16_f32 v58, v35, v39
    v_cvt_pk_bf16_f32 v57, v42, v46
    global_store_dwordx4 v240, v[56:59], s[60:61] offset:128 sc1
    v_cvt_pk_bf16_f32 v60, v41, v45
    v_cvt_pk_bf16_f32 v61, v43, v47
    global_store_dwordx4 v240, v[60:63], s[60:61] offset:256 sc1
    s_mov_b32 exec_lo, 0x1010101
    s_mov_b32 exec_hi, 0x1010101
    global_store_dword v241, v9, s[60:61] sc1
    s_mov_b64 exec, -1
    s_mov_b32 s5, 0
L_f3_29:
    s_load_dwordx8 s[64:71], s[26:27], 0 glc
    s_add_u32 s5, s5, 1
    s_cmp_ge_u32 s5, 1000000
    s_cbranch_scc1 L_bail
    s_waitcnt lgkmcnt(0)
    s_xor_b64 s[64:65], s[64:65], s[18:19]
    s_xor_b64 s[66:67], s[66:67], s[18:19]
    s_xor_b64 s[68:69], s[68:69], s[18:19]
    s_xor_b64 s[70:71], s[70:71], s[18:19]
    s_or_b64 s[64:65], s[64:65], s[66:67]
    s_or_b64 s[68:69], s[68:69], s[70:71]
    s_or_b64 s[64:65], s[64:65], s[68:69]
    s_cbranch_scc1 L_f3_29
    global_load_dwordx4 v[96:99], v205, s[60:61] offset:0 sc1
    global_load_dwordx4 v[100:103], v205, s[60:61] offset:128 sc1
    global_load_dwordx4 v[104:107], v205, s[60:61] offset:256 sc1
    v_add_u32 v246, 0x20000, v246
    global_load_dwordx4 v[236:239], v246, s[44:45] nt
    s_mov_b32 s5, 0
    s_waitcnt vmcnt(1)
    v_xor_b32 v21, v9, v99
    v_bitop3_b32 v21, v103, v9, v21 bitop3:0xbe
    v_bitop3_b32 v21, v107, v9, v21 bitop3:0xbe
    v_cmp_ne_u32 vcc, 0, v21
    s_nop 1
    s_and_b64 exec, vcc, vcc
    s_cbranch_scc0 L_h3ok_31
L_h3_30:
    global_load_dwordx4 v[96:99], v205, s[60:61] offset:0 sc1
    global_load_dwordx4 v[100:103], v205, s[60:61] offset:128 sc1
    global_load_dwordx4 v[104:107], v205, s[60:61] offset:256 sc1
    s_add_u32 s5, s5, 1
    s_cmp_ge_u32 s5, 1000000
    s_cbranch_scc1 L_bail
    s_waitcnt vmcnt(0)
    v_xor_b32 v21, v9, v99
    v_bitop3_b32 v21, v103, v9, v21 bitop3:0xbe
    v_bitop3_b32 v21, v107, v9, v21 bitop3:0xbe
    v_cmp_ne_u32 vcc, 0, v21
    s_nop 1
    s_and_b64 exec, vcc, vcc
    s_cbranch_scc1 L_h3_30
L_h3ok_31:
    s_mov_b64 exec, -1
    s_nop 0
    v_mov_b32_dpp v108, v106 quad_perm:[0,0,0,0] row_mask:0xf bank_mask:0xf
    v_mov_b32_dpp v109, v106 quad_perm:[1,1,1,1] row_mask:0xf bank_mask:0xf
    v_mov_b32_dpp v110, v106 quad_perm:[2,2,2,2] row_mask:0xf bank_mask:0xf
    v_mov_b32_dpp v111, v106 quad_perm:[3,3,3,3] row_mask:0xf bank_mask:0xf
    v_mov_b32 v99, v104
    v_mov_b32 v103, v105
    v_max_f32_dpp v112, v108, v108 row_ror:8 row_mask:0xf bank_mask:0xf
    v_max_f32_dpp v114, v109, v109 row_ror:8 row_mask:0xf bank_mask:0xf
    v_mov_b32 v116, v112
    v_mov_b32 v117, v114
    s_nop 0
    v_permlane16_swap_b32 v112, v116
    v_permlane16_swap_b32 v114, v117
    v_max_f32 v112, v112, v116
    v_max_f32 v114, v114, v117
    v_mov_b32 v116, v112
    v_mov_b32 v117, v114
    s_nop 0
    v_permlane32_swap_b32 v112, v116
    v_permlane32_swap_b32 v114, v117
    v_max_f32 v112, v112, v116
    v_max_f32 v114, v114, v117
    v_sub_f32 v108, v108, v112
    v_sub_f32 v109, v109, v114
    v_exp_f32 v108, v108
    v_exp_f32 v109, v109
    v_cvt_pk_bf16_f32 v108, v108, v108
    v_cvt_pk_bf16_f32 v109, v109, v109
    v_and_b32 v116, v108, v5
    v_and_b32 v117, v108, v6
    v_and_b32 v118, v108, v7
    v_and_b32 v119, v108, v8
    v_and_b32 v120, v109, v5
    v_and_b32 v121, v109, v6
    v_and_b32 v122, v109, v7
    v_and_b32 v123, v109, v8
    v_mfma_f32_16x16x32_bf16 v[32:35], v[116:119], v[96:99], 0
    s_nop 0
    v_mfma_f32_16x16x32_bf16 v[36:39], v[120:123], v[100:103], 0
    v_and_b32 v108, 0xffff0000, v108
    v_and_b32 v109, 0xffff0000, v109
    v_mul_f32 v113, v108, v110
    v_mul_f32 v115, v109, v111
    s_nop 0
    v_add_f32_dpp v113, v113, v113 row_ror:8 row_mask:0xf bank_mask:0xf
    v_add_f32_dpp v115, v115, v115 row_ror:8 row_mask:0xf bank_mask:0xf
    v_mov_b32 v124, v113
    v_mov_b32 v125, v115
    s_nop 0
    v_permlane16_swap_b32 v113, v124
    v_permlane16_swap_b32 v115, v125
    v_add_f32 v113, v113, v124
    v_add_f32 v115, v115, v125
    v_mov_b32 v124, v113
    v_mov_b32 v125, v115
    s_nop 0
    v_permlane32_swap_b32 v113, v124
    v_permlane32_swap_b32 v115, v125
    v_add_f32 v113, v113, v124
    v_add_f32 v115, v115, v125
    s_mov_b32 exec_lo, 0xff00ff
    s_mov_b32 exec_hi, 0xff00ff00
    ds_write_b128 v206, v[32:35] offset:0
    ds_write_b128 v206, v[36:39] offset:512
    s_mov_b32 exec_lo, 0x11
    s_mov_b32 exec_hi, 0x0
    ds_write_b64 v207, v[112:113] offset:16384
    ds_write_b64 v207, v[114:115] offset:16512
    s_mov_b64 exec, -1
    global_load_dwordx4 v[64:67], v245, s[46:47] offset:0 nt
    global_load_dwordx4 v[68:71], v245, s[46:47] offset:1152 nt
    s_cmp_lg_u32 s3, 7
    s_cbranch_scc1 L_x8_32
    global_load_dwordx4 v[80:83], v247, s[46:47] offset:0 nt
    global_load_dwordx4 v[84:87], v247, s[46:47] offset:1152 nt
L_x8_32:
    v_add_u32 v245, 9216, v245
    global_load_dwordx4 v[72:75], v245, s[46:47] offset:0 nt
    global_load_dwordx4 v[76:79], v245, s[46:47] offset:1152 nt
    s_cmp_lg_u32 s3, 7
    s_cbranch_scc1 L_x8_33
    v_add_u32 v247, 9216, v247
    global_load_dwordx4 v[88:91], v247, s[46:47] offset:0 nt
    global_load_dwordx4 v[92:95], v247, s[46:47] offset:1152 nt
L_x8_33:
    s_waitcnt lgkmcnt(0)
    s_barrier
    ds_read_b64 v[112:113], v213 offset:16384
    ds_read_b128 v[32:35], v212 offset:0
    ds_read_b128 v[36:39], v212 offset:128
    s_waitcnt lgkmcnt(2)
    v_max_f32_dpp v114, v112, v112 quad_perm:[1,0,3,2] row_mask:0xf bank_mask:0xf
    s_nop 1
    v_max_f32_dpp v114, v114, v114 quad_perm:[2,3,0,1] row_mask:0xf bank_mask:0xf
    s_waitcnt lgkmcnt(0)
    v_add_f32 v32, v32, v36
    v_add_f32 v33, v33, v37
    v_max_f32_dpp v114, v114, v114 row_half_mirror row_mask:0xf bank_mask:0xf
    v_add_f32 v34, v34, v38
    v_add_f32 v35, v35, v39
    v_sub_f32 v112, v112, v114
    v_exp_f32 v112, v112
    s_nop 0
    v_mul_f32 v113, v112, v113
    v_mul_f32 v32, v112, v32
    v_mul_f32 v33, v112, v33
    v_mul_f32 v34, v112, v34
    v_mul_f32 v35, v112, v35
    v_add_f32_dpp v113, v113, v113 quad_perm:[1,0,3,2] row_mask:0xf bank_mask:0xf
    v_add_f32_dpp v32, v32, v32 quad_perm:[1,0,3,2] row_mask:0xf bank_mask:0xf
    v_add_f32_dpp v33, v33, v33 quad_perm:[1,0,3,2] row_mask:0xf bank_mask:0xf
    v_add_f32_dpp v34, v34, v34 quad_perm:[1,0,3,2] row_mask:0xf bank_mask:0xf
    v_add_f32_dpp v35, v35, v35 quad_perm:[1,0,3,2] row_mask:0xf bank_mask:0xf
    v_add_f32_dpp v113, v113, v113 quad_perm:[2,3,0,1] row_mask:0xf bank_mask:0xf
    v_add_f32_dpp v32, v32, v32 quad_perm:[2,3,0,1] row_mask:0xf bank_mask:0xf
    v_add_f32_dpp v33, v33, v33 quad_perm:[2,3,0,1] row_mask:0xf bank_mask:0xf
    v_add_f32_dpp v34, v34, v34 quad_perm:[2,3,0,1] row_mask:0xf bank_mask:0xf
    v_add_f32_dpp v35, v35, v35 quad_perm:[2,3,0,1] row_mask:0xf bank_mask:0xf
    v_add_f32_dpp v113, v113, v113 row_half_mirror row_mask:0xf bank_mask:0xf
    v_add_f32_dpp v32, v32, v32 row_half_mirror row_mask:0xf bank_mask:0xf
    v_add_f32_dpp v33, v33, v33 row_half_mirror row_mask:0xf bank_mask:0xf
    v_add_f32_dpp v34, v34, v34 row_half_mirror row_mask:0xf bank_mask:0xf
    v_add_f32_dpp v35, v35, v35 row_half_mirror row_mask:0xf bank_mask:0xf
    v_rcp_f32 v113, v113
    s_nop 0
    v_mul_f32 v32, v113, v32
    v_mul_f32 v33, v113, v33
    v_mul_f32 v34, v113, v34
    v_mul_f32 v35, v113, v35
    v_cvt_pk_bf16_f32 v48, v32, v32
    v_cvt_pk_bf16_f32 v49, v33, v33
    v_cvt_pk_bf16_f32 v50, v34, v34
    v_cvt_pk_bf16_f32 v51, v35, v35
    v_and_b32 v176, v48, v5
    v_and_b32 v177, v48, v6
    v_and_b32 v178, v48, v7
    v_and_b32 v179, v48, v8
    v_and_b32 v180, v49, v5
    v_and_b32 v181, v49, v6
    v_and_b32 v182, v49, v7
    v_and_b32 v183, v49, v8
    v_and_b32 v184, v50, v5
    v_and_b32 v185, v50, v6
    v_and_b32 v186, v50, v7
    v_and_b32 v187, v50, v8
    v_and_b32 v188, v51, v5
    v_and_b32 v189, v51, v6
    v_and_b32 v190, v51, v7
    v_and_b32 v191, v51, v8
    s_cmp_eq_u32 s3, 7
    s_cbranch_scc1 L_wv_34
    s_waitcnt vmcnt(4)
L_wv_34:
    s_waitcnt vmcnt(8)
    v_mfma_f32_16x16x32_bf16 v[40:43], v[176:179], v[224:227], 0
    v_mfma_f32_16x16x32_bf16 v[40:43], v[180:183], v[228:231], v[40:43]
    v_mfma_f32_16x16x32_bf16 v[40:43], v[184:187], v[232:235], v[40:43]
    v_mfma_f32_16x16x32_bf16 v[40:43], v[188:191], v[236:239], v[40:43]
    s_nop 7
    v_permlane32_swap_b32 v40, v42
    v_permlane32_swap_b32 v41, v43
    s_nop 0
    v_add_f32_dpp v40, v42, v40 row_ror:8 row_mask:0xf bank_mask:0xf
    v_add_f32_dpp v41, v43, v41 row_ror:8 row_mask:0xf bank_mask:0xf
    v_cvt_pk_bf16_f32 v40, v40, v41
    v_mov_b32 v41, v9
    s_mov_b32 exec_lo, 0xff00ff
    s_mov_b32 exec_hi, 0xff00ff
    s_cmp_lg_u32 s101, 0
    s_cbranch_scc1 L_gs_35
    global_store_dwordx2 v242, v[40:41], s[60:61] sc1
    s_branch L_gs_36
L_gs_35:
    global_store_dwordx2 v242, v[40:41], s[60:61]
L_gs_36:
    s_mov_b64 exec, -1
    s_cmp_lg_u32 s3, 0
    s_cbranch_scc1 L_x9_37
    s_cmp_lg_u32 s101, 0
    s_cbranch_scc1 L_gd_38
    s_waitcnt vmcnt(0)
L_gd_38:
    global_load_dwordx4 v[96:99], v214, s[60:61] offset:0 sc1
    global_load_dwordx4 v[100:103], v214, s[60:61] offset:1024 sc1
    s_mov_b32 s5, 0
    s_waitcnt vmcnt(0)
    v_xor_b32 v21, v9, v97
    v_bitop3_b32 v21, v99, v9, v21 bitop3:0xbe
    v_bitop3_b32 v21, v101, v9, v21 bitop3:0xbe
    v_bitop3_b32 v21, v103, v9, v21 bitop3:0xbe
    v_cmp_ne_u32 vcc, 0, v21
    s_nop 1
    s_and_b64 exec, vcc, vcc
    s_cbranch_scc0 L_h4ok_40
L_h4_39:
    global_load_dwordx4 v[96:99], v214, s[60:61] offset:0 sc1
    global_load_dwordx4 v[100:103], v214, s[60:61] offset:1024 sc1
    s_add_u32 s5, s5, 1
    s_cmp_ge_u32 s5, 1000000
    s_cbranch_scc1 L_bail
    s_waitcnt vmcnt(0)
    v_xor_b32 v21, v9, v97
    v_bitop3_b32 v21, v99, v9, v21 bitop3:0xbe
    v_bitop3_b32 v21, v101, v9, v21 bitop3:0xbe
    v_bitop3_b32 v21, v103, v9, v21 bitop3:0xbe
    v_cmp_ne_u32 vcc, 0, v21
    s_nop 1
    s_and_b64 exec, vcc, vcc
    s_cbranch_scc1 L_h4_39
L_h4ok_40:
    s_mov_b64 exec, -1
    v_lshlrev_b32 v32, 16, v96
    v_and_b32 v33, 0xffff0000, v96
    v_lshlrev_b32 v34, 16, v98
    v_and_b32 v35, 0xffff0000, v98
    v_lshlrev_b32 v36, 16, v100
    v_and_b32 v37, 0xffff0000, v100
    v_lshlrev_b32 v38, 16, v102
    v_and_b32 v39, 0xffff0000, v102
    v_add_f32 v32, v32, v36
    v_add_f32 v33, v33, v37
    v_add_f32 v34, v34, v38
    v_add_f32 v35, v35, v39
    v_add_f32_dpp v32, v32, v32 quad_perm:[1,0,3,2] row_mask:0xf bank_mask:0xf
    v_add_f32_dpp v33, v33, v33 quad_perm:[1,0,3,2] row_mask:0xf bank_mask:0xf
    v_add_f32_dpp v34, v34, v34 quad_perm:[1,0,3,2] row_mask:0xf bank_mask:0xf
    v_add_f32_dpp v35, v35, v35 quad_perm:[1,0,3,2] row_mask:0xf bank_mask:0xf
    v_add_f32_dpp v32, v32, v32 quad_perm:[2,3,0,1] row_mask:0xf bank_mask:0xf
    v_add_f32_dpp v33, v33, v33 quad_perm:[2,3,0,1] row_mask:0xf bank_mask:0xf
    v_add_f32_dpp v34, v34, v34 quad_perm:[2,3,0,1] row_mask:0xf bank_mask:0xf
    v_add_f32_dpp v35, v35, v35 quad_perm:[2,3,0,1] row_mask:0xf bank_mask:0xf
    v_add_f32_dpp v32, v32, v32 row_half_mirror row_mask:0xf bank_mask:0xf
    v_add_f32_dpp v33, v33, v33 row_half_mirror row_mask:0xf bank_mask:0xf
    v_add_f32_dpp v34, v34, v34 row_half_mirror row_mask:0xf bank_mask:0xf
    v_add_f32_dpp v35, v35, v35 row_half_mirror row_mask:0xf bank_mask:0xf
    ds_write_b128 v20, v[32:35] offset:20480
    s_waitcnt lgkmcnt(0)
L_x9_37:
    s_barrier
    ds_read_b128 v[32:35], v20 offset:20480
    s_waitcnt lgkmcnt(0)
    v_cvt_pk_bf16_f32 v48, v32, v32
    v_cvt_pk_bf16_f32 v49, v33, v33
    v_cvt_pk_bf16_f32 v50, v34, v34
    v_cvt_pk_bf16_f32 v51, v35, v35
    v_and_b32 v176, v48, v5
    v_and_b32 v177, v48, v6
    v_and_b32 v178, v48, v7
    v_and_b32 v179, v48, v8
    v_and_b32 v180, v49, v5
    v_and_b32 v181, v49, v6
    v_and_b32 v182, v49, v7
    v_and_b32 v183, v49, v8
    v_and_b32 v184, v50, v5
    v_and_b32 v185, v50, v6
    v_and_b32 v186, v50, v7
    v_and_b32 v187, v50, v8
    v_and_b32 v188, v51, v5
    v_and_b32 v189, v51, v6
    v_and_b32 v190, v51, v7
    v_and_b32 v191, v51, v8
    s_waitcnt vmcnt(0)
    s_cmp_eq_u32 s3, 7
    s_cbranch_scc1 L_c2b8_41
    v_mfma_f32_16x16x32_bf16 v[40:43], v[176:179], v[64:67], 0
    v_mfma_f32_16x16x32_bf16 v[40:43], v[180:183], v[68:71], v[40:43]
    v_mfma_f32_16x16x32_bf16 v[40:43], v[184:187], v[72:75], v[40:43]
    v_mfma_f32_16x16x32_bf16 v[40:43], v[188:191], v[76:79], v[40:43]
    s_nop 7
    v_permlane32_swap_b32 v40, v42
    v_permlane32_swap_b32 v41, v43
    s_nop 0
    v_add_f32_dpp v40, v42, v40 row_ror:8 row_mask:0xf bank_mask:0xf
    v_add_f32_dpp v41, v43, v41 row_ror:8 row_mask:0xf bank_mask:0xf
    v_cvt_pk_bf16_f32 v40, v40, v41
    v_mov_b32 v41, v9
    s_mov_b32 exec_lo, 0xff00ff
    s_mov_b32 exec_hi, 0xff00ff
    global_store_dwordx2 v243, v[40:41], s[60:61] sc1
    s_branch L_c2e_42
L_c2b8_41:
    v_mfma_f32_16x16x32_bf16 v[40:43], v[176:179], v[64:67], 0
    v_mfma_f32_16x16x32_bf16 v[44:47], v[176:179], v[80:83], 0
    v_mfma_f32_16x16x32_bf16 v[40:43], v[180:183], v[68:71], v[40:43]
    v_mfma_f32_16x16x32_bf16 v[44:47], v[180:183], v[84:87], v[44:47]
    v_mfma_f32_16x16x32_bf16 v[40:43], v[184:187], v[72:75], v[40:43]
    v_mfma_f32_16x16x32_bf16 v[44:47], v[184:187], v[88:91], v[44:47]
    v_mfma_f32_16x16x32_bf16 v[40:43], v[188:191], v[76:79], v[40:43]
    v_mfma_f32_16x16x32_bf16 v[44:47], v[188:191], v[92:95], v[44:47]
    s_nop 6
    v_permlane32_swap_b32 v40, v42
    v_permlane32_swap_b32 v41, v43
    v_permlane32_swap_b32 v44, v46
    v_permlane32_swap_b32 v45, v47
    v_add_f32_dpp v40, v42, v40 row_ror:8 row_mask:0xf bank_mask:0xf
    v_add_f32_dpp v41, v43, v41 row_ror:8 row_mask:0xf bank_mask:0xf
    v_add_f32_dpp v44, v46, v44 row_ror:8 row_mask:0xf bank_mask:0xf
    v_add_f32_dpp v45, v47, v45 row_ror:8 row_mask:0xf bank_mask:0xf
    v_cvt_pk_bf16_f32 v40, v40, v41
    v_mov_b32 v41, v9
    v_cvt_pk_bf16_f32 v44, v44, v45
    v_mov_b32 v45, v9
    s_mov_b32 exec_lo, 0xff00ff
    s_mov_b32 exec_hi, 0xff00ff
    global_store_dwordx2 v243, v[40:41], s[60:61] sc1
    global_store_dwordx2 v244, v[44:45], s[60:61] sc1
L_c2e_42:
    s_mov_b64 exec, -1
    s_waitcnt vmcnt(0)
    s_barrier
    s_sub_u32 s6, s3, 4
    s_cmp_gt_u32 s6, 1
    s_cbranch_scc1 L_end
    s_cmp_ge_u32 s4, 36
    s_cbranch_scc1 L_end
    v_and_b32 v32, 0x3f803f80, v5
    v_mov_b32 v33, 0
    v_and_b32 v34, 0x3f803f80, v7
    v_mov_b32 v35, 0
    s_waitcnt vmcnt(0)
    global_load_dwordx4 v[96:99], v215, s[60:61] offset:-4096 sc1
    global_load_dwordx4 v[100:103], v215, s[60:61] offset:-2048 sc1
    global_load_dwordx4 v[104:107], v215, s[60:61] offset:0 sc1
    global_load_dwordx4 v[108:111], v215, s[60:61] offset:2048 sc1
    global_load_dwordx4 v[112:115], v216, s[60:61] offset:-4096 sc1
    global_load_dwordx4 v[116:119], v216, s[60:61] offset:-2048 sc1
    global_load_dwordx4 v[120:123], v216, s[60:61] offset:0 sc1
    global_load_dwordx4 v[124:127], v216, s[60:61] offset:2048 sc1
    s_mov_b32 s5, 0
    s_waitcnt vmcnt(0)
    v_xor_b32 v21, v9, v97
    v_xor_b32 v22, v9, v99
    v_bitop3_b32 v21, v101, v9, v21 bitop3:0xbe
    v_bitop3_b32 v22, v103, v9, v22 bitop3:0xbe
    v_bitop3_b32 v21, v105, v9, v21 bitop3:0xbe
    v_bitop3_b32 v22, v107, v9, v22 bitop3:0xbe
    v_bitop3_b32 v21, v109, v9, v21 bitop3:0xbe
    v_bitop3_b32 v22, v111, v9, v22 bitop3:0xbe
    v_bitop3_b32 v21, v113, v9, v21 bitop3:0xbe
    v_bitop3_b32 v22, v115, v9, v22 bitop3:0xbe
    v_bitop3_b32 v21, v117, v9, v21 bitop3:0xbe
    v_bitop3_b32 v22, v119, v9, v22 bitop3:0xbe
    v_bitop3_b32 v21, v121, v9, v21 bitop3:0xbe
    v_bitop3_b32 v22, v123, v9, v22 bitop3:0xbe
    v_bitop3_b32 v21, v125, v9, v21 bitop3:0xbe
    v_bitop3_b32 v22, v127, v9, v22 bitop3:0xbe
    v_or_b32 v21, v21, v22
    v_cmp_ne_u32 vcc, 0, v21
    s_nop 1
    s_and_b64 exec, vcc, vcc
    s_cbranch_scc0 L_h5ok_44
L_h5_43:
    global_load_dwordx4 v[96:99], v215, s[60:61] offset:-4096 sc1
    global_load_dwordx4 v[100:103], v215, s[60:61] offset:-2048 sc1
    global_load_dwordx4 v[104:107], v215, s[60:61] offset:0 sc1
    global_load_dwordx4 v[108:111], v215, s[60:61] offset:2048 sc1
    global_load_dwordx4 v[112:115], v216, s[60:61] offset:-4096 sc1
    global_load_dwordx4 v[116:119], v216, s[60:61] offset:-2048 sc1
    global_load_dwordx4 v[120:123], v216, s[60:61] offset:0 sc1
    global_load_dwordx4 v[124:127], v216, s[60:61] offset:2048 sc1
    s_add_u32 s5, s5, 1
    s_cmp_ge_u32 s5, 1000000
    s_cbranch_scc1 L_bail
    s_waitcnt vmcnt(0)
    v_xor_b32 v21, v9, v97
    v_xor_b32 v22, v9, v99
    v_bitop3_b32 v21, v101, v9, v21 bitop3:0xbe
    v_bitop3_b32 v22, v103, v9, v22 bitop3:0xbe
    v_bitop3_b32 v21, v105, v9, v21 bitop3:0xbe
    v_bitop3_b32 v22, v107, v9, v22 bitop3:0xbe
    v_bitop3_b32 v21, v109, v9, v21 bitop3:0xbe
    v_bitop3_b32 v22, v111, v9, v22 bitop3:0xbe
    v_bitop3_b32 v21, v113, v9, v21 bitop3:0xbe
    v_bitop3_b32 v22, v115, v9, v22 bitop3:0xbe
    v_bitop3_b32 v21, v117, v9, v21 bitop3:0xbe
    v_bitop3_b32 v22, v119, v9, v22 bitop3:0xbe
    v_bitop3_b32 v21, v121, v9, v21 bitop3:0xbe
    v_bitop3_b32 v22, v123, v9, v22 bitop3:0xbe
    v_bitop3_b32 v21, v125, v9, v21 bitop3:0xbe
    v_bitop3_b32 v22, v127, v9, v22 bitop3:0xbe
    v_or_b32 v21, v21, v22
    v_cmp_ne_u32 vcc, 0, v21
    s_nop 1
    s_and_b64 exec, vcc, vcc
    s_cbranch_scc1 L_h5_43
L_h5ok_44:
    s_mov_b64 exec, -1
    s_nop 0
    v_mfma_f32_16x16x32_bf16 v[36:39], v[32:35], v[96:99], 0
    v_mfma_f32_16x16x32_bf16 v[40:43], v[32:35], v[100:103], 0
    v_mfma_f32_16x16x32_bf16 v[36:39], v[32:35], v[104:107], v[36:39]
    v_mfma_f32_16x16x32_bf16 v[40:43], v[32:35], v[108:111], v[40:43]
    v_mfma_f32_16x16x32_bf16 v[36:39], v[32:35], v[112:115], v[36:39]
    v_mfma_f32_16x16x32_bf16 v[40:43], v[32:35], v[116:119], v[40:43]
    v_mfma_f32_16x16x32_bf16 v[36:39], v[32:35], v[120:123], v[36:39]
    v_mfma_f32_16x16x32_bf16 v[40:43], v[32:35], v[124:127], v[40:43]
    s_nop 7
    v_add_f32 v36, v36, v40
    v_add_f32 v37, v37, v41
    s_nop 0
    v_add_f32_dpp v36, v36, v36 row_ror:4 row_mask:0xf bank_mask:0xf
    v_add_f32_dpp v37, v37, v37 row_ror:4 row_mask:0xf bank_mask:0xf
    s_nop 0
    v_add_f32_dpp v36, v36, v36 row_ror:8 row_mask:0xf bank_mask:0xf
    v_add_f32_dpp v37, v37, v37 row_ror:8 row_mask:0xf bank_mask:0xf
    v_cvt_pk_bf16_f32 v36, v36, v37
    s_mov_b32 exec_lo, 0xf000f
    s_mov_b32 exec_hi, 0x0
    global_store_dword v217, v36, s[58:59]
    s_lshl_b32 s6, s4, 3
    s_or_b32 s6, s6, s3
    s_cmp_lg_u32 s6, 4
    s_cbranch_scc1 L_fin
    s_mov_b64 exec, 1
    v_mov_b32 v36, s62
    v_mov_b32 v37, 0
    global_store_dword v37, v36, s[60:61]
L_fin:
    s_mov_b64 exec, -1
    s_branch L_end
L_bail:
    s_mov_b64 exec, -1
L_end:
L_exit:
    s_endpgm
L_codeend:
.section .rodata,"a"
.p2align 6
.amdhsa_kernel concat_heads__compressed_kv_cla__sliding_block_cached__decode_kernel
  .amdhsa_next_free_vgpr 256
  .amdhsa_next_free_sgpr 102
  .amdhsa_accum_offset 256
  .amdhsa_group_segment_fixed_size 0
  .amdhsa_kernarg_size 112
  .amdhsa_user_sgpr_count 2
  .amdhsa_user_sgpr_kernarg_segment_ptr 1
  .amdhsa_system_sgpr_workgroup_id_x 1
.end_amdhsa_kernel
```
